```python
import torch

def _softmax(x, axis=-1):
    return torch.softmax(x, dim=axis)
def _gelu(x):
    return torch.nn.functional.gelu(x, approximate="tanh")
def _silu(x):
    return torch.nn.functional.silu(x)
def _sigmoid(x):
    return torch.sigmoid(x)
def _layernorm(x, axis=-1, eps=1e-5):
    m = x.mean(dim=axis, keepdim=True)
    v = x.var(dim=axis, keepdim=True, unbiased=False)
    return (x - m) / torch.sqrt(v + eps)
def _scatter_add(tgt, idx, src, axis=0):
    return tgt.clone().index_add_(axis, idx, src)
def _segment_sum(src, seg, n):
    out = torch.zeros((n,) + src.shape[1:], dtype=src.dtype)
    return out.index_add_(0, seg, src)
def _pad(x, pw):
    flat = tuple(v for pair in reversed(pw) for v in pair)
    return torch.nn.functional.pad(x, flat)

kernel_name = 'recurrent_scan__ssm_conv_s4d__dense_activation_mish__prompt'

def setup_inputs():

    _w = (lambda a: (lambda t: t.to(torch.bfloat16) if t.is_floating_point() else t)(torch.as_tensor(a)))
    def _A_setup():
        Bsz, L, D, N = 1, 2048, 448, 256
        return {
            "u": _w((lambda *s: torch.randn(*s, dtype=torch.bfloat16) * 0.05)(Bsz, L, D)),
            "log_A_real": _w((lambda *s: torch.randn(*s, dtype=torch.bfloat16) * 3.2)(D, N) * 0.5),
            "A_imag": _w((lambda *s: torch.randn(*s, dtype=torch.bfloat16) * 0.2)(D, N) * 3.14),
            "C_real": _w((lambda *s: torch.randn(*s, dtype=torch.bfloat16) * 0.8)(D, N) / N ** 0.5),
            "C_imag": _w((lambda *s: torch.randn(*s, dtype=torch.bfloat16) * 0.8)(D, N) / N ** 0.5),
            "log_dt": _w((lambda *s: torch.randn(*s, dtype=torch.bfloat16) * 0.2)(D) * 0.5 - 4.0),
            "D_skip": _w((lambda *s: torch.randn(*s, dtype=torch.bfloat16) * 0.2)(D)),
        }
    _A_in = _A_setup()

    def _B_setup():
        B, S, D, F = 1, 2048, 448, 1792
        return {
            "x": _w((lambda *s: torch.randn(*s, dtype=torch.bfloat16) * 0.05)(B, S, D)),
            "w1": _w((lambda *s: torch.randn(*s, dtype=torch.bfloat16) * 0.8)(D, F) * (D ** -0.5)),
            "b1": _w((lambda *s: torch.randn(*s, dtype=torch.bfloat16) * 0.4)(F)),
            "w2": _w((lambda *s: torch.randn(*s, dtype=torch.bfloat16) * 0.1)(F, D) * (F ** -0.5)),
        }
    _B_in = _B_setup()

    return {
        "A_u": _A_in["u"],
        "A_log_A_real": _A_in["log_A_real"],
        "A_A_imag": _A_in["A_imag"],
        "A_C_real": _A_in["C_real"],
        "A_C_imag": _A_in["C_imag"],
        "A_log_dt": _A_in["log_dt"],
        "A_D_skip": _A_in["D_skip"],
        "B_x": _B_in["x"],
        "B_w1": _B_in["w1"],
        "B_b1": _B_in["b1"],
        "B_w2": _B_in["w2"],
    }

def reference(A_u, A_log_A_real, A_A_imag, A_C_real, A_C_imag, A_log_dt, A_D_skip, B_x, B_w1, B_b1, B_w2):
    def _A_ref(u, log_A_real, A_imag, C_real, C_imag, log_dt, D_skip):
        L = u.shape[1]
        dt = torch.exp(log_dt)
        A = -torch.exp(log_A_real) + 1j * A_imag
        C = (C_real + 1j * C_imag) * dt[:, None]
        pos = (lambda x, dt: x.to(dt))(torch.arange(L), log_dt.dtype)
        P = torch.exp((A * dt[:, None])[:, :, None] * pos[None, None, :])
        K = 2.0 * torch.einsum("dn,dnl->dl", C, P).real
        L2 = 2 * L
        u_t = (lambda x, *d: x.permute(*d))(u, 0, 2, 1)
        Kf = (lambda x, *a, **k: torch.fft.rfft(x.float(), *a, **k))(K, L2)
        Uf = (lambda x, *a, **k: torch.fft.rfft(x.float(), *a, **k))(u_t, L2)
        y = (lambda x, *a, **k: torch.fft.irfft(x, *a, **k).to(torch.bfloat16))(Uf * Kf[None, :, :], L2)[:, :, :L]
        y = (lambda x, *d: x.permute(*d))(y, 0, 2, 1)
        return y + u * D_skip[None, None, :]

    def _B_ref(x, w1, b1, w2):
        h = torch.einsum("bsd,df->bsf", x, w1) + b1
        sp = torch.log1p(torch.exp(-torch.abs(h))) + torch.where(h > 0, h, torch.zeros_like(h))
        act = h * torch.tanh(sp)
        return torch.einsum("bsf,fd->bsd", act, w2)

    x = A_u
    xn = _layernorm(x, axis=-1)
    s = _A_ref(xn, A_log_A_real, A_A_imag, A_C_real, A_C_imag, A_log_dt, A_D_skip)
    g = _silu(_B_ref(xn, B_w1, B_b1, B_w2))
    return x + s * g
```

```asm
; @launch grid=(512,1,1) block=(256,1,1) lds=81920
.amdgcn_target "amdgcn-amd-amdhsa--gfx950"
.text
.globl recurrent_scan__ssm_conv_s4d__dense_activation_mish__prompt_kernel
.p2align 8
.type recurrent_scan__ssm_conv_s4d__dense_activation_mish__prompt_kernel,@function
recurrent_scan__ssm_conv_s4d__dense_activation_mish__prompt_kernel:
s_cmp_ge_u32 s2, 512
s_cbranch_scc1 L_end
s_cmp_ge_u32 s2, 288
s_cbranch_scc1 L_typeA
s_cmp_ge_u32 s2, 64
s_cbranch_scc1 L_typeB
s_cmp_lg_u32 s2, 0
s_cbranch_scc1 L_nm_1
s_load_dwordx2 s[62:63], s[0:1], 96
s_memrealtime s[60:61]
s_waitcnt lgkmcnt(0)
s_or_b32 s60, s60, 1
v_mov_b32 v1, s60
v_mov_b32 v2, 0
v_cmp_eq_u32 vcc, 0, v0
s_and_saveexec_b64 s[60:61], vcc
s_cbranch_execz L_nm_1_r
global_store_dword v2, v1, s[62:63] sc1
L_nm_1_r:
s_mov_b64 exec, s[60:61]
L_nm_1:

s_setprio 3
s_load_dwordx2 s[36:37], s[0:1], 0
s_load_dwordx2 s[42:43], s[0:1], 104
s_load_dwordx2 s[62:63], s[0:1], 96
v_lshrrev_b32 v1, 3, v0
v_and_b32 v2, 7, v0
v_mul_u32_u24 v3, 896, v1
v_lshl_add_u32 v3, v2, 4, v3
s_mul_i32 s24, s2, 28672
s_waitcnt lgkmcnt(0)

s_mov_b32 s4, s36
s_mov_b32 s5, s37
s_mov_b32 s6, 1835008
s_mov_b32 s7, 0x20000
buffer_load_dwordx4 v[16:19], v3, s[4:7], s24 offen offset:0
buffer_load_dwordx4 v[20:23], v3, s[4:7], s24 offen offset:128
buffer_load_dwordx4 v[24:27], v3, s[4:7], s24 offen offset:256
buffer_load_dwordx4 v[28:31], v3, s[4:7], s24 offen offset:384
buffer_load_dwordx4 v[32:35], v3, s[4:7], s24 offen offset:512
buffer_load_dwordx4 v[36:39], v3, s[4:7], s24 offen offset:640
buffer_load_dwordx4 v[40:43], v3, s[4:7], s24 offen offset:768
v_mov_b32 v61, 0
global_load_dword v60, v61, s[62:63] sc1
s_add_u32 s16, s42, 8388608
s_addc_u32 s17, s43, 0
s_mov_b32 s18, 1835008
s_mov_b32 s19, 0x20000
s_add_u32 s44, s42, 16777216
s_addc_u32 s45, s43, 0
s_mov_b32 s46, 65536
s_mov_b32 s47, 0x20000
v_mov_b32 v4, 0
v_mov_b32 v5, 0
v_mov_b32 v6, 0
v_mov_b32 v7, 0
v_mov_b32 v8, 0x3f803f80
v_mul_u32_u24 v9, 576, v2
v_lshl_add_u32 v9, v1, 1, v9
s_waitcnt vmcnt(1)

v_dot2c_f32_bf16 v4, v16, v8
v_dot2c_f32_bf16 v6, v16, v16
v_dot2c_f32_bf16 v5, v17, v8
v_dot2c_f32_bf16 v7, v17, v17
v_dot2c_f32_bf16 v4, v18, v8
v_dot2c_f32_bf16 v6, v18, v18
v_dot2c_f32_bf16 v5, v19, v8
v_dot2c_f32_bf16 v7, v19, v19
v_dot2c_f32_bf16 v4, v20, v8
v_dot2c_f32_bf16 v6, v20, v20
v_dot2c_f32_bf16 v5, v21, v8
v_dot2c_f32_bf16 v7, v21, v21
v_dot2c_f32_bf16 v4, v22, v8
v_dot2c_f32_bf16 v6, v22, v22
v_dot2c_f32_bf16 v5, v23, v8
v_dot2c_f32_bf16 v7, v23, v23
v_dot2c_f32_bf16 v4, v24, v8
v_dot2c_f32_bf16 v6, v24, v24
v_dot2c_f32_bf16 v5, v25, v8
v_dot2c_f32_bf16 v7, v25, v25
v_dot2c_f32_bf16 v4, v26, v8
v_dot2c_f32_bf16 v6, v26, v26
v_dot2c_f32_bf16 v5, v27, v8
v_dot2c_f32_bf16 v7, v27, v27
v_dot2c_f32_bf16 v4, v28, v8
v_dot2c_f32_bf16 v6, v28, v28
v_dot2c_f32_bf16 v5, v29, v8
v_dot2c_f32_bf16 v7, v29, v29
v_dot2c_f32_bf16 v4, v30, v8
v_dot2c_f32_bf16 v6, v30, v30
v_dot2c_f32_bf16 v5, v31, v8
v_dot2c_f32_bf16 v7, v31, v31
v_dot2c_f32_bf16 v4, v32, v8
v_dot2c_f32_bf16 v6, v32, v32
v_dot2c_f32_bf16 v5, v33, v8
v_dot2c_f32_bf16 v7, v33, v33
v_dot2c_f32_bf16 v4, v34, v8
v_dot2c_f32_bf16 v6, v34, v34
v_dot2c_f32_bf16 v5, v35, v8
v_dot2c_f32_bf16 v7, v35, v35
v_dot2c_f32_bf16 v4, v36, v8
v_dot2c_f32_bf16 v6, v36, v36
v_dot2c_f32_bf16 v5, v37, v8
v_dot2c_f32_bf16 v7, v37, v37
v_dot2c_f32_bf16 v4, v38, v8
v_dot2c_f32_bf16 v6, v38, v38
v_dot2c_f32_bf16 v5, v39, v8
v_dot2c_f32_bf16 v7, v39, v39
v_dot2c_f32_bf16 v4, v40, v8
v_dot2c_f32_bf16 v6, v40, v40
v_dot2c_f32_bf16 v5, v41, v8
v_dot2c_f32_bf16 v7, v41, v41
v_dot2c_f32_bf16 v4, v42, v8
v_dot2c_f32_bf16 v6, v42, v42
v_dot2c_f32_bf16 v5, v43, v8
v_dot2c_f32_bf16 v7, v43, v43
s_nop 3
v_add_f32 v4, v4, v5
v_add_f32 v6, v6, v7
s_nop 1
v_add_f32_dpp v4, v4, v4 quad_perm:[1,0,3,2] row_mask:0xf bank_mask:0xf
v_add_f32_dpp v6, v6, v6 quad_perm:[1,0,3,2] row_mask:0xf bank_mask:0xf
s_nop 1
v_add_f32_dpp v4, v4, v4 quad_perm:[2,3,0,1] row_mask:0xf bank_mask:0xf
v_add_f32_dpp v6, v6, v6 quad_perm:[2,3,0,1] row_mask:0xf bank_mask:0xf
s_nop 1
v_add_f32_dpp v4, v4, v4 row_half_mirror row_mask:0xf bank_mask:0xf
v_add_f32_dpp v6, v6, v6 row_half_mirror row_mask:0xf bank_mask:0xf
s_nop 1
v_mul_f32 v4, 991054117, v4
v_mul_f32 v6, 991054117, v6
v_fma_f32 v6, -v4, v4, v6
v_max_f32 v6, 0, v6
v_cvt_pk_bf16_f32 v5, v4, v6
v_and_b32 v7, 0xffff0000, v5
v_lshlrev_b32 v4, 16, v5
v_add_f32 v7, 925353388, v7
v_cvt_pk_bf16_f32 v7, v7, v7
v_and_b32 v7, 0xffff0000, v7
v_sqrt_f32 v7, v7
s_nop 0
v_cvt_pk_bf16_f32 v7, v7, v7
v_and_b32 v6, 0xffff0000, v7
v_rcp_f32 v10, v6
v_lshrrev_b32 v11, 16, v4
v_or_b32 v13, v11, v6

s_waitcnt vmcnt(0)
v_readfirstlane_b32 s69, v60
s_mov_b32 s61, 20000
s_nop 1
s_cmp_lg_u32 s69, 0
s_cbranch_scc1 L_nf_2_d
L_nf_2:
global_load_dword v60, v61, s[62:63] sc1
s_waitcnt vmcnt(0)
v_readfirstlane_b32 s69, v60
s_sub_u32 s61, s61, 1
s_cbranch_scc1 L_nf_2_d
s_cmp_eq_u32 s69, 0
s_cbranch_scc1 L_nf_2
L_nf_2_d:

v_mov_b32 v12, s69
v_lshlrev_b32 v14, 3, v1
s_lshl_b32 s25, s2, 8
s_add_u32 s25, s25, 49152
v_cmp_eq_u32 vcc, 0, v2
s_and_saveexec_b64 s[60:61], vcc
s_cbranch_execz L_ln_3
buffer_store_dwordx2 v[12:13], v14, s[44:47], s25 offen sc1
L_ln_3:
s_mov_b64 exec, s[60:61]

v_lshlrev_b32 v44, 16, v16
v_lshlrev_b32 v48, 16, v17
v_lshlrev_b32 v52, 16, v18
v_lshlrev_b32 v56, 16, v19
v_and_b32 v45, 0xffff0000, v16
v_and_b32 v49, 0xffff0000, v17
v_and_b32 v53, 0xffff0000, v18
v_and_b32 v57, 0xffff0000, v19
v_sub_f32 v44, v44, v4
v_sub_f32 v48, v48, v4
v_sub_f32 v52, v52, v4
v_sub_f32 v56, v56, v4
v_sub_f32 v45, v45, v4
v_sub_f32 v49, v49, v4
v_sub_f32 v53, v53, v4
v_sub_f32 v57, v57, v4
v_cvt_pk_bf16_f32 v46, v44, v45
v_cvt_pk_bf16_f32 v50, v48, v49
v_cvt_pk_bf16_f32 v54, v52, v53
v_cvt_pk_bf16_f32 v58, v56, v57
v_lshlrev_b32 v44, 16, v46
v_lshlrev_b32 v48, 16, v50
v_lshlrev_b32 v52, 16, v54
v_lshlrev_b32 v56, 16, v58
v_and_b32 v45, 0xffff0000, v46
v_and_b32 v49, 0xffff0000, v50
v_and_b32 v53, 0xffff0000, v54
v_and_b32 v57, 0xffff0000, v58
v_mul_f32 v44, v44, v10
v_mul_f32 v48, v48, v10
v_mul_f32 v52, v52, v10
v_mul_f32 v56, v56, v10
v_mul_f32 v45, v45, v10
v_mul_f32 v49, v49, v10
v_mul_f32 v53, v53, v10
v_mul_f32 v57, v57, v10
v_cvt_pk_bf16_f32 v16, v44, v45
v_cvt_pk_bf16_f32 v17, v48, v49
v_cvt_pk_bf16_f32 v18, v52, v53
v_cvt_pk_bf16_f32 v19, v56, v57
ds_write_b16 v9, v16 offset:0
ds_write_b16 v9, v17 offset:144
ds_write_b16 v9, v18 offset:288
ds_write_b16 v9, v19 offset:432
ds_write_b16_d16_hi v9, v16 offset:72
ds_write_b16_d16_hi v9, v17 offset:216
ds_write_b16_d16_hi v9, v18 offset:360
ds_write_b16_d16_hi v9, v19 offset:504

v_lshlrev_b32 v44, 16, v20
v_lshlrev_b32 v48, 16, v21
v_lshlrev_b32 v52, 16, v22
v_lshlrev_b32 v56, 16, v23
v_and_b32 v45, 0xffff0000, v20
v_and_b32 v49, 0xffff0000, v21
v_and_b32 v53, 0xffff0000, v22
v_and_b32 v57, 0xffff0000, v23
v_sub_f32 v44, v44, v4
v_sub_f32 v48, v48, v4
v_sub_f32 v52, v52, v4
v_sub_f32 v56, v56, v4
v_sub_f32 v45, v45, v4
v_sub_f32 v49, v49, v4
v_sub_f32 v53, v53, v4
v_sub_f32 v57, v57, v4
v_cvt_pk_bf16_f32 v46, v44, v45
v_cvt_pk_bf16_f32 v50, v48, v49
v_cvt_pk_bf16_f32 v54, v52, v53
v_cvt_pk_bf16_f32 v58, v56, v57
v_lshlrev_b32 v44, 16, v46
v_lshlrev_b32 v48, 16, v50
v_lshlrev_b32 v52, 16, v54
v_lshlrev_b32 v56, 16, v58
v_and_b32 v45, 0xffff0000, v46
v_and_b32 v49, 0xffff0000, v50
v_and_b32 v53, 0xffff0000, v54
v_and_b32 v57, 0xffff0000, v58
v_mul_f32 v44, v44, v10
v_mul_f32 v48, v48, v10
v_mul_f32 v52, v52, v10
v_mul_f32 v56, v56, v10
v_mul_f32 v45, v45, v10
v_mul_f32 v49, v49, v10
v_mul_f32 v53, v53, v10
v_mul_f32 v57, v57, v10
v_cvt_pk_bf16_f32 v20, v44, v45
v_cvt_pk_bf16_f32 v21, v48, v49
v_cvt_pk_bf16_f32 v22, v52, v53
v_cvt_pk_bf16_f32 v23, v56, v57
ds_write_b16 v9, v20 offset:4608
ds_write_b16 v9, v21 offset:4752
ds_write_b16 v9, v22 offset:4896
ds_write_b16 v9, v23 offset:5040
ds_write_b16_d16_hi v9, v20 offset:4680
ds_write_b16_d16_hi v9, v21 offset:4824
ds_write_b16_d16_hi v9, v22 offset:4968
ds_write_b16_d16_hi v9, v23 offset:5112

v_lshlrev_b32 v44, 16, v24
v_lshlrev_b32 v48, 16, v25
v_lshlrev_b32 v52, 16, v26
v_lshlrev_b32 v56, 16, v27
v_and_b32 v45, 0xffff0000, v24
v_and_b32 v49, 0xffff0000, v25
v_and_b32 v53, 0xffff0000, v26
v_and_b32 v57, 0xffff0000, v27
v_sub_f32 v44, v44, v4
v_sub_f32 v48, v48, v4
v_sub_f32 v52, v52, v4
v_sub_f32 v56, v56, v4
v_sub_f32 v45, v45, v4
v_sub_f32 v49, v49, v4
v_sub_f32 v53, v53, v4
v_sub_f32 v57, v57, v4
v_cvt_pk_bf16_f32 v46, v44, v45
v_cvt_pk_bf16_f32 v50, v48, v49
v_cvt_pk_bf16_f32 v54, v52, v53
v_cvt_pk_bf16_f32 v58, v56, v57
v_lshlrev_b32 v44, 16, v46
v_lshlrev_b32 v48, 16, v50
v_lshlrev_b32 v52, 16, v54
v_lshlrev_b32 v56, 16, v58
v_and_b32 v45, 0xffff0000, v46
v_and_b32 v49, 0xffff0000, v50
v_and_b32 v53, 0xffff0000, v54
v_and_b32 v57, 0xffff0000, v58
v_mul_f32 v44, v44, v10
v_mul_f32 v48, v48, v10
v_mul_f32 v52, v52, v10
v_mul_f32 v56, v56, v10
v_mul_f32 v45, v45, v10
v_mul_f32 v49, v49, v10
v_mul_f32 v53, v53, v10
v_mul_f32 v57, v57, v10
v_cvt_pk_bf16_f32 v24, v44, v45
v_cvt_pk_bf16_f32 v25, v48, v49
v_cvt_pk_bf16_f32 v26, v52, v53
v_cvt_pk_bf16_f32 v27, v56, v57
ds_write_b16 v9, v24 offset:9216
ds_write_b16 v9, v25 offset:9360
ds_write_b16 v9, v26 offset:9504
ds_write_b16 v9, v27 offset:9648
ds_write_b16_d16_hi v9, v24 offset:9288
ds_write_b16_d16_hi v9, v25 offset:9432
ds_write_b16_d16_hi v9, v26 offset:9576
ds_write_b16_d16_hi v9, v27 offset:9720

v_lshlrev_b32 v44, 16, v28
v_lshlrev_b32 v48, 16, v29
v_lshlrev_b32 v52, 16, v30
v_lshlrev_b32 v56, 16, v31
v_and_b32 v45, 0xffff0000, v28
v_and_b32 v49, 0xffff0000, v29
v_and_b32 v53, 0xffff0000, v30
v_and_b32 v57, 0xffff0000, v31
v_sub_f32 v44, v44, v4
v_sub_f32 v48, v48, v4
v_sub_f32 v52, v52, v4
v_sub_f32 v56, v56, v4
v_sub_f32 v45, v45, v4
v_sub_f32 v49, v49, v4
v_sub_f32 v53, v53, v4
v_sub_f32 v57, v57, v4
v_cvt_pk_bf16_f32 v46, v44, v45
v_cvt_pk_bf16_f32 v50, v48, v49
v_cvt_pk_bf16_f32 v54, v52, v53
v_cvt_pk_bf16_f32 v58, v56, v57
v_lshlrev_b32 v44, 16, v46
v_lshlrev_b32 v48, 16, v50
v_lshlrev_b32 v52, 16, v54
v_lshlrev_b32 v56, 16, v58
v_and_b32 v45, 0xffff0000, v46
v_and_b32 v49, 0xffff0000, v50
v_and_b32 v53, 0xffff0000, v54
v_and_b32 v57, 0xffff0000, v58
v_mul_f32 v44, v44, v10
v_mul_f32 v48, v48, v10
v_mul_f32 v52, v52, v10
v_mul_f32 v56, v56, v10
v_mul_f32 v45, v45, v10
v_mul_f32 v49, v49, v10
v_mul_f32 v53, v53, v10
v_mul_f32 v57, v57, v10
v_cvt_pk_bf16_f32 v28, v44, v45
v_cvt_pk_bf16_f32 v29, v48, v49
v_cvt_pk_bf16_f32 v30, v52, v53
v_cvt_pk_bf16_f32 v31, v56, v57
ds_write_b16 v9, v28 offset:13824
ds_write_b16 v9, v29 offset:13968
ds_write_b16 v9, v30 offset:14112
ds_write_b16 v9, v31 offset:14256
ds_write_b16_d16_hi v9, v28 offset:13896
ds_write_b16_d16_hi v9, v29 offset:14040
ds_write_b16_d16_hi v9, v30 offset:14184
ds_write_b16_d16_hi v9, v31 offset:14328

v_lshlrev_b32 v44, 16, v32
v_lshlrev_b32 v48, 16, v33
v_lshlrev_b32 v52, 16, v34
v_lshlrev_b32 v56, 16, v35
v_and_b32 v45, 0xffff0000, v32
v_and_b32 v49, 0xffff0000, v33
v_and_b32 v53, 0xffff0000, v34
v_and_b32 v57, 0xffff0000, v35
v_sub_f32 v44, v44, v4
v_sub_f32 v48, v48, v4
v_sub_f32 v52, v52, v4
v_sub_f32 v56, v56, v4
v_sub_f32 v45, v45, v4
v_sub_f32 v49, v49, v4
v_sub_f32 v53, v53, v4
v_sub_f32 v57, v57, v4
v_cvt_pk_bf16_f32 v46, v44, v45
v_cvt_pk_bf16_f32 v50, v48, v49
v_cvt_pk_bf16_f32 v54, v52, v53
v_cvt_pk_bf16_f32 v58, v56, v57
v_lshlrev_b32 v44, 16, v46
v_lshlrev_b32 v48, 16, v50
v_lshlrev_b32 v52, 16, v54
v_lshlrev_b32 v56, 16, v58
v_and_b32 v45, 0xffff0000, v46
v_and_b32 v49, 0xffff0000, v50
v_and_b32 v53, 0xffff0000, v54
v_and_b32 v57, 0xffff0000, v58
v_mul_f32 v44, v44, v10
v_mul_f32 v48, v48, v10
v_mul_f32 v52, v52, v10
v_mul_f32 v56, v56, v10
v_mul_f32 v45, v45, v10
v_mul_f32 v49, v49, v10
v_mul_f32 v53, v53, v10
v_mul_f32 v57, v57, v10
v_cvt_pk_bf16_f32 v32, v44, v45
v_cvt_pk_bf16_f32 v33, v48, v49
v_cvt_pk_bf16_f32 v34, v52, v53
v_cvt_pk_bf16_f32 v35, v56, v57
ds_write_b16 v9, v32 offset:18432
ds_write_b16 v9, v33 offset:18576
ds_write_b16 v9, v34 offset:18720
ds_write_b16 v9, v35 offset:18864
ds_write_b16_d16_hi v9, v32 offset:18504
ds_write_b16_d16_hi v9, v33 offset:18648
ds_write_b16_d16_hi v9, v34 offset:18792
ds_write_b16_d16_hi v9, v35 offset:18936

v_lshlrev_b32 v44, 16, v36
v_lshlrev_b32 v48, 16, v37
v_lshlrev_b32 v52, 16, v38
v_lshlrev_b32 v56, 16, v39
v_and_b32 v45, 0xffff0000, v36
v_and_b32 v49, 0xffff0000, v37
v_and_b32 v53, 0xffff0000, v38
v_and_b32 v57, 0xffff0000, v39
v_sub_f32 v44, v44, v4
v_sub_f32 v48, v48, v4
v_sub_f32 v52, v52, v4
v_sub_f32 v56, v56, v4
v_sub_f32 v45, v45, v4
v_sub_f32 v49, v49, v4
v_sub_f32 v53, v53, v4
v_sub_f32 v57, v57, v4
v_cvt_pk_bf16_f32 v46, v44, v45
v_cvt_pk_bf16_f32 v50, v48, v49
v_cvt_pk_bf16_f32 v54, v52, v53
v_cvt_pk_bf16_f32 v58, v56, v57
v_lshlrev_b32 v44, 16, v46
v_lshlrev_b32 v48, 16, v50
v_lshlrev_b32 v52, 16, v54
v_lshlrev_b32 v56, 16, v58
v_and_b32 v45, 0xffff0000, v46
v_and_b32 v49, 0xffff0000, v50
v_and_b32 v53, 0xffff0000, v54
v_and_b32 v57, 0xffff0000, v58
v_mul_f32 v44, v44, v10
v_mul_f32 v48, v48, v10
v_mul_f32 v52, v52, v10
v_mul_f32 v56, v56, v10
v_mul_f32 v45, v45, v10
v_mul_f32 v49, v49, v10
v_mul_f32 v53, v53, v10
v_mul_f32 v57, v57, v10
v_cvt_pk_bf16_f32 v36, v44, v45
v_cvt_pk_bf16_f32 v37, v48, v49
v_cvt_pk_bf16_f32 v38, v52, v53
v_cvt_pk_bf16_f32 v39, v56, v57
ds_write_b16 v9, v36 offset:23040
ds_write_b16 v9, v37 offset:23184
ds_write_b16 v9, v38 offset:23328
ds_write_b16 v9, v39 offset:23472
ds_write_b16_d16_hi v9, v36 offset:23112
ds_write_b16_d16_hi v9, v37 offset:23256
ds_write_b16_d16_hi v9, v38 offset:23400
ds_write_b16_d16_hi v9, v39 offset:23544

v_lshlrev_b32 v44, 16, v40
v_lshlrev_b32 v48, 16, v41
v_lshlrev_b32 v52, 16, v42
v_lshlrev_b32 v56, 16, v43
v_and_b32 v45, 0xffff0000, v40
v_and_b32 v49, 0xffff0000, v41
v_and_b32 v53, 0xffff0000, v42
v_and_b32 v57, 0xffff0000, v43
v_sub_f32 v44, v44, v4
v_sub_f32 v48, v48, v4
v_sub_f32 v52, v52, v4
v_sub_f32 v56, v56, v4
v_sub_f32 v45, v45, v4
v_sub_f32 v49, v49, v4
v_sub_f32 v53, v53, v4
v_sub_f32 v57, v57, v4
v_cvt_pk_bf16_f32 v46, v44, v45
v_cvt_pk_bf16_f32 v50, v48, v49
v_cvt_pk_bf16_f32 v54, v52, v53
v_cvt_pk_bf16_f32 v58, v56, v57
v_lshlrev_b32 v44, 16, v46
v_lshlrev_b32 v48, 16, v50
v_lshlrev_b32 v52, 16, v54
v_lshlrev_b32 v56, 16, v58
v_and_b32 v45, 0xffff0000, v46
v_and_b32 v49, 0xffff0000, v50
v_and_b32 v53, 0xffff0000, v54
v_and_b32 v57, 0xffff0000, v58
v_mul_f32 v44, v44, v10
v_mul_f32 v48, v48, v10
v_mul_f32 v52, v52, v10
v_mul_f32 v56, v56, v10
v_mul_f32 v45, v45, v10
v_mul_f32 v49, v49, v10
v_mul_f32 v53, v53, v10
v_mul_f32 v57, v57, v10
v_cvt_pk_bf16_f32 v40, v44, v45
v_cvt_pk_bf16_f32 v41, v48, v49
v_cvt_pk_bf16_f32 v42, v52, v53
v_cvt_pk_bf16_f32 v43, v56, v57
ds_write_b16 v9, v40 offset:27648
ds_write_b16 v9, v41 offset:27792
ds_write_b16 v9, v42 offset:27936
ds_write_b16 v9, v43 offset:28080
ds_write_b16_d16_hi v9, v40 offset:27720
ds_write_b16_d16_hi v9, v41 offset:27864
ds_write_b16_d16_hi v9, v42 offset:28008
ds_write_b16_d16_hi v9, v43 offset:28152

v_lshrrev_b32 v1, 2, v0
v_and_b32 v2, 3, v0
v_mul_u32_u24 v3, 72, v1
v_lshl_add_u32 v3, v2, 4, v3
v_lshlrev_b32 v9, 12, v1
v_lshl_add_u32 v9, v2, 4, v9
s_lshl_b32 s25, s2, 6
s_waitcnt lgkmcnt(0)
s_barrier

ds_read2_b64 v[16:19], v3 offset0:0 offset1:1
v_add_u32 v3, 4608, v3
ds_read2_b64 v[20:23], v3 offset0:0 offset1:1
v_add_u32 v3, 4608, v3
ds_read2_b64 v[24:27], v3 offset0:0 offset1:1
v_add_u32 v3, 4608, v3
ds_read2_b64 v[28:31], v3 offset0:0 offset1:1
v_add_u32 v3, 4608, v3
ds_read2_b64 v[32:35], v3 offset0:0 offset1:1
v_add_u32 v3, 4608, v3
ds_read2_b64 v[36:39], v3 offset0:0 offset1:1
v_add_u32 v3, 4608, v3
ds_read2_b64 v[40:43], v3 offset0:0 offset1:1
v_add_u32 v3, 4608, v3
s_waitcnt lgkmcnt(6)
buffer_store_dwordx4 v[16:19], v9, s[16:19], s25 offen sc1
s_add_u32 s25, s25, 262144
s_waitcnt lgkmcnt(5)
buffer_store_dwordx4 v[20:23], v9, s[16:19], s25 offen sc1
s_add_u32 s25, s25, 262144
s_waitcnt lgkmcnt(4)
buffer_store_dwordx4 v[24:27], v9, s[16:19], s25 offen sc1
s_add_u32 s25, s25, 262144
s_waitcnt lgkmcnt(3)
buffer_store_dwordx4 v[28:31], v9, s[16:19], s25 offen sc1
s_add_u32 s25, s25, 262144
s_waitcnt lgkmcnt(2)
buffer_store_dwordx4 v[32:35], v9, s[16:19], s25 offen sc1
s_add_u32 s25, s25, 262144
s_waitcnt lgkmcnt(1)
buffer_store_dwordx4 v[36:39], v9, s[16:19], s25 offen sc1
s_add_u32 s25, s25, 262144
s_waitcnt lgkmcnt(0)
buffer_store_dwordx4 v[40:43], v9, s[16:19], s25 offen sc1
s_add_u32 s25, s25, 262144
s_lshl_b32 s25, s2, 6
s_add_u32 s25, s25, 16384
s_waitcnt vmcnt(0)
s_barrier
v_cmp_eq_u32 vcc, 0, v0
s_and_saveexec_b64 s[60:61], vcc
s_cbranch_execz L_sg_4
v_mov_b32 v44, s69
v_mov_b32 v45, 0
buffer_store_dword v44, v45, s[44:47], s25 offen sc1
L_sg_4:
s_mov_b64 exec, s[60:61]

s_branch L_fin
L_typeB:
s_sub_u32 s2, s2, 64
s_setprio 1
s_load_dwordx2 s[62:63], s[0:1], 96
s_load_dwordx2 s[36:37], s[0:1], 0
s_load_dwordx2 s[38:39], s[0:1], 64
s_load_dwordx2 s[40:41], s[0:1], 72
s_load_dwordx2 s[42:43], s[0:1], 104
v_lshrrev_b32 v1, 6, v0
v_and_b32 v2, 63, v0
s_and_b32 s31, s2, 7
s_lshr_b32 s32, s2, 3
v_readfirstlane_b32 s24, v1
s_and_b32 s25, s31, 3
s_lshl_b32 s25, s25, 2
s_and_b32 s33, s32, 3
s_add_u32 s25, s25, s33
s_lshr_b32 s31, s31, 2
s_mul_i32 s31, s31, 7
s_lshr_b32 s32, s32, 2
s_add_u32 s26, s31, s32

v_lshrrev_b32 v3, 2, v2
v_mul_u32_u24 v10, 896, v3
v_and_b32 v56, 3, v2
v_lshrrev_b32 v57, 4, v2
v_and_b32 v57, 3, v57
v_xor_b32 v58, v56, v57
v_lshl_add_u32 v10, v58, 4, v10
v_lshrrev_b32 v58, 4, v2
v_mul_u32_u24 v11, 3584, v58
v_lshrrev_b32 v59, 2, v2
v_and_b32 v59, 3, v59
v_xor_b32 v59, v59, v57
v_lshl_add_u32 v11, v59, 6, v11
v_lshl_add_u32 v11, v56, 4, v11
s_waitcnt lgkmcnt(0)

s_mov_b32 s4, s36
s_mov_b32 s5, s37
s_mov_b32 s6, 1835008
s_mov_b32 s7, 0x20000
s_mov_b32 s8, s38
s_mov_b32 s9, s39
s_mov_b32 s10, 1605632
s_mov_b32 s11, 0x20000
s_mov_b32 s20, s40
s_mov_b32 s21, s41
s_mov_b32 s22, 3584
s_mov_b32 s23, 0x20000
s_mov_b32 s12, s42
s_mov_b32 s13, s43
s_mov_b32 s14, 7340032
s_mov_b32 s15, 0x20000
s_add_u32 s16, s42, 8388608
s_addc_u32 s17, s43, 0
s_mov_b32 s18, 1835008
s_mov_b32 s19, 0x20000
s_mul_i32 s28, s25, 114688
s_mul_i32 s31, s24, 28672
s_add_u32 s28, s28, s31
s_mul_i32 s29, s24, 28672
s_lshl_b32 s31, s26, 8
s_add_u32 s29, s29, s31
s_lshl_b32 s30, s24, 11
s_add_u32 s27, s26, 1
s_cmp_eq_u32 s27, 14
s_cselect_b32 s27, 0, s27

v_add_u32 v138, 14336, v10
v_add_u32 v139, 14336, v11
s_lshl_b32 s31, s27, 6
s_add_u32 s48, s28, s31
s_mul_i32 s31, s27, 114688
s_add_u32 s49, s29, s31
s_add_u32 s50, s28, 896

v_and_b32 v56, 31, v2
v_lshlrev_b32 v56, 1, v56
s_lshl_b32 s31, s26, 8

s_add_u32 s32, s24, 0
s_and_b32 s32, s32, 3
s_lshl_b32 s32, s32, 6
s_add_u32 s32, s32, s31
buffer_load_ushort v60, v56, s[20:23], s32 offen

s_add_u32 s32, s24, 1
s_and_b32 s32, s32, 3
s_lshl_b32 s32, s32, 6
s_add_u32 s32, s32, s31
buffer_load_ushort v61, v56, s[20:23], s32 offen

s_add_u32 s32, s24, 2
s_and_b32 s32, s32, 3
s_lshl_b32 s32, s32, 6
s_add_u32 s32, s32, s31
buffer_load_ushort v62, v56, s[20:23], s32 offen

s_add_u32 s32, s24, 3
s_and_b32 s32, s32, 3
s_lshl_b32 s32, s32, 6
s_add_u32 s32, s32, s31
buffer_load_ushort v63, v56, s[20:23], s32 offen

s_add_u32 m0, s30, 0
s_nop 0
buffer_load_dwordx4 v10, s[4:7], s48 offen lds
s_add_u32 m0, s30, 1024
s_nop 0
buffer_load_dwordx4 v138, s[4:7], s48 offen lds
s_add_u32 s48, s48, 64
s_add_u32 m0, s30, 8192
s_nop 0
buffer_load_dwordx4 v11, s[8:11], s49 offen lds
s_add_u32 m0, s30, 9216
s_nop 0
buffer_load_dwordx4 v139, s[8:11], s49 offen lds
s_add_u32 s49, s49, 114688
s_cmp_eq_u32 s48, s50
s_cselect_b32 s48, s28, s48
s_cselect_b32 s49, s29, s49
s_add_u32 m0, s30, 16384
s_nop 0
buffer_load_dwordx4 v10, s[4:7], s48 offen lds
s_add_u32 m0, s30, 17408
s_nop 0
buffer_load_dwordx4 v138, s[4:7], s48 offen lds
s_add_u32 s48, s48, 64
s_add_u32 m0, s30, 24576
s_nop 0
buffer_load_dwordx4 v11, s[8:11], s49 offen lds
s_add_u32 m0, s30, 25600
s_nop 0
buffer_load_dwordx4 v139, s[8:11], s49 offen lds
s_add_u32 s49, s49, 114688
s_cmp_eq_u32 s48, s50
s_cselect_b32 s48, s28, s48
s_cselect_b32 s49, s29, s49
v_and_b32 v56, 31, v2
v_lshrrev_b32 v57, 5, v2
v_lshrrev_b32 v58, 2, v56
v_and_b32 v58, 3, v58
v_xor_b32 v58, v58, v57
v_lshlrev_b32 v58, 4, v58
v_lshl_add_u32 v58, v56, 6, v58
s_lshl_b32 s31, s24, 11
v_add_u32 v8, s31, v58
v_xor_b32 v9, 32, v8
v_and_b32 v56, 15, v2
v_lshrrev_b32 v58, 2, v56
v_and_b32 v59, 3, v56
v_lshl_add_u32 v1, v57, 3, v58
v_lshlrev_b32 v1, 8, v1
v_lshl_add_u32 v1, v59, 3, v1
v_lshrrev_b32 v3, 4, v2
v_and_b32 v3, 1, v3
v_lshl_add_u32 v1, v3, 5, v1

s_add_u32 s32, s24, 0
s_and_b32 s32, s32, 3
v_xor_b32 v3, s32, v58
v_lshl_add_u32 v4, v3, 6, v1

s_add_u32 s32, s24, 1
s_and_b32 s32, s32, 3
v_xor_b32 v3, s32, v58
v_lshl_add_u32 v5, v3, 6, v1

s_add_u32 s32, s24, 2
s_and_b32 s32, s32, 3
v_xor_b32 v3, s32, v58
v_lshl_add_u32 v6, v3, 6, v1

s_add_u32 s32, s24, 3
s_and_b32 s32, s32, 3
v_xor_b32 v3, s32, v58
v_lshl_add_u32 v7, v3, 6, v1

v_mov_b32 v12, 0
v_mov_b32 v13, 0
v_mov_b32 v14, 0
v_mov_b32 v15, 0x3f803f80
v_mov_b32 v64, 0
v_mov_b32 v65, 0
v_mov_b32 v66, 0
v_mov_b32 v67, 0
v_mov_b32 v68, 0
v_mov_b32 v69, 0
v_mov_b32 v70, 0
v_mov_b32 v71, 0
v_mov_b32 v72, 0
v_mov_b32 v73, 0
v_mov_b32 v74, 0
v_mov_b32 v75, 0
v_mov_b32 v76, 0
v_mov_b32 v77, 0
v_mov_b32 v78, 0
v_mov_b32 v79, 0
v_mov_b32 v80, 0
v_mov_b32 v81, 0
v_mov_b32 v82, 0
v_mov_b32 v83, 0
v_mov_b32 v84, 0
v_mov_b32 v85, 0
v_mov_b32 v86, 0
v_mov_b32 v87, 0
v_mov_b32 v88, 0
v_mov_b32 v89, 0
v_mov_b32 v90, 0
v_mov_b32 v91, 0
v_mov_b32 v92, 0
v_mov_b32 v93, 0
v_mov_b32 v94, 0
v_mov_b32 v95, 0
v_mov_b32 v96, 0
v_mov_b32 v97, 0
v_mov_b32 v98, 0
v_mov_b32 v99, 0
v_mov_b32 v100, 0
v_mov_b32 v101, 0
v_mov_b32 v102, 0
v_mov_b32 v103, 0
v_mov_b32 v104, 0
v_mov_b32 v105, 0
v_mov_b32 v106, 0
v_mov_b32 v107, 0
v_mov_b32 v108, 0
v_mov_b32 v109, 0
v_mov_b32 v110, 0
v_mov_b32 v111, 0
v_mov_b32 v112, 0
v_mov_b32 v113, 0
v_mov_b32 v114, 0
v_mov_b32 v115, 0
v_mov_b32 v116, 0
v_mov_b32 v117, 0
v_mov_b32 v118, 0
v_mov_b32 v119, 0
v_mov_b32 v120, 0
v_mov_b32 v121, 0
v_mov_b32 v122, 0
v_mov_b32 v123, 0
v_mov_b32 v124, 0
v_mov_b32 v125, 0
v_mov_b32 v126, 0
v_mov_b32 v127, 0
v_mov_b32 v140, 0
v_mov_b32 v141, 0
v_mov_b32 v142, 0
v_mov_b32 v143, 0
v_mov_b32 v144, 0
v_mov_b32 v145, 0
v_mov_b32 v146, 0
v_mov_b32 v147, 0
v_mov_b32 v148, 0
v_mov_b32 v149, 0
v_mov_b32 v150, 0
v_mov_b32 v151, 0
v_mov_b32 v152, 0
v_mov_b32 v153, 0
v_mov_b32 v154, 0
v_mov_b32 v155, 0
v_mov_b32 v156, 0
v_mov_b32 v157, 0
v_mov_b32 v158, 0
v_mov_b32 v159, 0
v_mov_b32 v160, 0
v_mov_b32 v161, 0
v_mov_b32 v162, 0
v_mov_b32 v163, 0
v_and_b32 v56, 3, v2
v_lshrrev_b32 v57, 2, v2
v_lshrrev_b32 v58, 4, v2
v_xor_b32 v57, v57, v58
v_and_b32 v57, 1, v57
v_or_b32 v56, v56, v57
v_cmp_eq_u32 vcc, 0, v56
s_nop 1
v_cndmask_b32 v164, 0, v15, vcc
v_cndmask_b32 v165, 0, v15, vcc
v_cndmask_b32 v166, 0, v15, vcc
v_cndmask_b32 v167, 0, v15, vcc

v_add_u32 v132, 65536, v4
v_add_u32 v133, 65536, v5
v_add_u32 v134, 65536, v6
v_add_u32 v135, 65536, v7
v_add_u32 v136, 65536, v8
v_add_u32 v137, 65536, v9
s_add_u32 m0, s30, 32768
s_nop 0
buffer_load_dwordx4 v10, s[4:7], s48 offen lds
s_add_u32 m0, s30, 33792
s_nop 0
buffer_load_dwordx4 v138, s[4:7], s48 offen lds
s_add_u32 s48, s48, 64
s_add_u32 m0, s30, 40960
s_nop 0
buffer_load_dwordx4 v11, s[8:11], s49 offen lds
s_add_u32 m0, s30, 41984
s_nop 0
buffer_load_dwordx4 v139, s[8:11], s49 offen lds
s_add_u32 s49, s49, 114688
s_cmp_eq_u32 s48, s50
s_cselect_b32 s48, s28, s48
s_cselect_b32 s49, s29, s49
s_add_u32 m0, s30, 49152
s_nop 0
buffer_load_dwordx4 v10, s[4:7], s48 offen lds
s_add_u32 m0, s30, 50176
s_nop 0
buffer_load_dwordx4 v138, s[4:7], s48 offen lds
s_add_u32 s48, s48, 64
s_add_u32 m0, s30, 57344
s_nop 0
buffer_load_dwordx4 v11, s[8:11], s49 offen lds
s_add_u32 m0, s30, 58368
s_nop 0
buffer_load_dwordx4 v139, s[8:11], s49 offen lds
s_add_u32 s49, s49, 114688
s_cmp_eq_u32 s48, s50
s_cselect_b32 s48, s28, s48
s_cselect_b32 s49, s29, s49
s_add_u32 m0, s30, 65536
s_nop 0
buffer_load_dwordx4 v10, s[4:7], s48 offen lds
s_add_u32 m0, s30, 66560
s_nop 0
buffer_load_dwordx4 v138, s[4:7], s48 offen lds
s_add_u32 s48, s48, 64
s_add_u32 m0, s30, 73728
s_nop 0
buffer_load_dwordx4 v11, s[8:11], s49 offen lds
s_add_u32 m0, s30, 74752
s_nop 0
buffer_load_dwordx4 v139, s[8:11], s49 offen lds
s_add_u32 s49, s49, 114688
s_cmp_eq_u32 s48, s50
s_cselect_b32 s48, s28, s48
s_cselect_b32 s49, s29, s49
v_mul_u32_u24 v58, 896, v0
v_mov_b32 v59, 0x7ffffff0
v_cmp_gt_u32 vcc, 128, v0
s_cmp_ge_u32 s26, 7
s_cselect_b32 s33, 7, 0
s_sub_u32 s33, s26, s33
s_lshl_b32 s33, s33, 7
s_mul_i32 s34, s25, 114688
s_add_u32 s33, s33, s34
v_cndmask_b32 v58, v59, v58, vcc
v_lshrrev_b32 v56, 1, v0
v_and_b32 v57, 1, v0
v_mul_u32_u24 v56, 3584, v56
v_lshl_add_u32 v56, v57, 7, v56
v_cmp_gt_u32 vcc, 224, v0
s_and_b32 s34, s25, 3
s_mul_i32 s34, s34, 401408
s_lshl_b32 s35, s26, 8
s_add_u32 s34, s34, s35
v_cndmask_b32 v56, v59, v56, vcc

buffer_load_dword v128, v58, s[4:7], s33 offen
buffer_load_dword v128, v56, s[8:11], s34 offen
s_waitcnt vmcnt(18)
s_barrier
ds_read_b128 v[48:51], v8 offset:0
ds_read_b64_tr_b16 v[16:17], v4 offset:8192
ds_read_b64_tr_b16 v[18:19], v4 offset:9216
ds_read_b64_tr_b16 v[20:21], v5 offset:8192
ds_read_b64_tr_b16 v[22:23], v5 offset:9216
ds_read_b64_tr_b16 v[24:25], v6 offset:8192
ds_read_b64_tr_b16 v[26:27], v6 offset:9216
ds_read_b64_tr_b16 v[28:29], v7 offset:8192
ds_read_b64_tr_b16 v[30:31], v7 offset:9216
s_waitcnt lgkmcnt(6)
v_mfma_f32_32x32x16_bf16 v[64:79], v[16:19], v[48:51], v[64:79]
ds_read_b128 v[52:55], v9 offset:0
ds_read_b64_tr_b16 v[32:33], v4 offset:12288
ds_read_b64_tr_b16 v[34:35], v4 offset:13312
s_waitcnt lgkmcnt(7)
v_mfma_f32_32x32x16_bf16 v[80:95], v[20:23], v[48:51], v[80:95]
ds_read_b64_tr_b16 v[36:37], v5 offset:12288
ds_read_b64_tr_b16 v[38:39], v5 offset:13312
ds_read_b64_tr_b16 v[40:41], v6 offset:12288
v_mfma_f32_16x16x32_bf16 v[160:163], v[164:167], v[16:19], v[160:163]
s_waitcnt lgkmcnt(8)
v_mfma_f32_32x32x16_bf16 v[96:111], v[24:27], v[48:51], v[96:111]
ds_read_b64_tr_b16 v[42:43], v6 offset:13312
ds_read_b64_tr_b16 v[44:45], v7 offset:12288
ds_read_b64_tr_b16 v[46:47], v7 offset:13312
s_waitcnt lgkmcnt(9)
v_mfma_f32_32x32x16_bf16 v[112:127], v[28:31], v[48:51], v[112:127]
s_waitcnt vmcnt(12) lgkmcnt(0)
s_barrier
v_mfma_f32_32x32x16_bf16 v[64:79], v[32:35], v[52:55], v[64:79]
ds_read_b128 v[48:51], v8 offset:16384
ds_read_b64_tr_b16 v[16:17], v4 offset:24576
ds_read_b64_tr_b16 v[18:19], v4 offset:25600
s_add_u32 m0, s30, 0
s_nop 0
buffer_load_dwordx4 v10, s[4:7], s48 offen lds
v_mfma_f32_32x32x16_bf16 v[80:95], v[36:39], v[52:55], v[80:95]
ds_read_b64_tr_b16 v[20:21], v5 offset:24576
ds_read_b64_tr_b16 v[22:23], v5 offset:25600
ds_read_b64_tr_b16 v[24:25], v6 offset:24576
s_add_u32 m0, s30, 1024
v_mfma_f32_16x16x32_bf16 v[160:163], v[164:167], v[32:35], v[160:163]
buffer_load_dwordx4 v138, s[4:7], s48 offen lds
s_add_u32 s48, s48, 64
v_mfma_f32_32x32x16_bf16 v[96:111], v[40:43], v[52:55], v[96:111]
ds_read_b64_tr_b16 v[26:27], v6 offset:25600
ds_read_b64_tr_b16 v[28:29], v7 offset:24576
ds_read_b64_tr_b16 v[30:31], v7 offset:25600
s_add_u32 m0, s30, 8192
s_nop 0
buffer_load_dwordx4 v11, s[8:11], s49 offen lds
v_mfma_f32_32x32x16_bf16 v[112:127], v[44:47], v[52:55], v[112:127]
s_add_u32 m0, s30, 9216
s_nop 0
buffer_load_dwordx4 v139, s[8:11], s49 offen lds
s_add_u32 s49, s49, 114688
s_cmp_eq_u32 s48, s50
s_cselect_b32 s48, s28, s48
s_cselect_b32 s49, s29, s49
s_waitcnt lgkmcnt(6)
v_mfma_f32_32x32x16_bf16 v[64:79], v[16:19], v[48:51], v[64:79]
ds_read_b128 v[52:55], v9 offset:16384
ds_read_b64_tr_b16 v[32:33], v4 offset:28672
ds_read_b64_tr_b16 v[34:35], v4 offset:29696
s_waitcnt lgkmcnt(7)
v_mfma_f32_32x32x16_bf16 v[80:95], v[20:23], v[48:51], v[80:95]
ds_read_b64_tr_b16 v[36:37], v5 offset:28672
ds_read_b64_tr_b16 v[38:39], v5 offset:29696
ds_read_b64_tr_b16 v[40:41], v6 offset:28672
v_mfma_f32_16x16x32_bf16 v[160:163], v[164:167], v[16:19], v[160:163]
s_waitcnt lgkmcnt(8)
v_mfma_f32_32x32x16_bf16 v[96:111], v[24:27], v[48:51], v[96:111]
ds_read_b64_tr_b16 v[42:43], v6 offset:29696
ds_read_b64_tr_b16 v[44:45], v7 offset:28672
ds_read_b64_tr_b16 v[46:47], v7 offset:29696
s_waitcnt lgkmcnt(9)
v_mfma_f32_32x32x16_bf16 v[112:127], v[28:31], v[48:51], v[112:127]
s_waitcnt vmcnt(12) lgkmcnt(0)
s_barrier
v_mfma_f32_32x32x16_bf16 v[64:79], v[32:35], v[52:55], v[64:79]
ds_read_b128 v[48:51], v8 offset:32768
ds_read_b64_tr_b16 v[16:17], v4 offset:40960
ds_read_b64_tr_b16 v[18:19], v4 offset:41984
s_add_u32 m0, s30, 16384
s_nop 0
buffer_load_dwordx4 v10, s[4:7], s48 offen lds
v_mfma_f32_32x32x16_bf16 v[80:95], v[36:39], v[52:55], v[80:95]
ds_read_b64_tr_b16 v[20:21], v5 offset:40960
ds_read_b64_tr_b16 v[22:23], v5 offset:41984
ds_read_b64_tr_b16 v[24:25], v6 offset:40960
s_add_u32 m0, s30, 17408
v_mfma_f32_16x16x32_bf16 v[160:163], v[164:167], v[32:35], v[160:163]
buffer_load_dwordx4 v138, s[4:7], s48 offen lds
s_add_u32 s48, s48, 64
v_mfma_f32_32x32x16_bf16 v[96:111], v[40:43], v[52:55], v[96:111]
ds_read_b64_tr_b16 v[26:27], v6 offset:41984
ds_read_b64_tr_b16 v[28:29], v7 offset:40960
ds_read_b64_tr_b16 v[30:31], v7 offset:41984
s_add_u32 m0, s30, 24576
s_nop 0
buffer_load_dwordx4 v11, s[8:11], s49 offen lds
v_mfma_f32_32x32x16_bf16 v[112:127], v[44:47], v[52:55], v[112:127]
s_add_u32 m0, s30, 25600
s_nop 0
buffer_load_dwordx4 v139, s[8:11], s49 offen lds
s_add_u32 s49, s49, 114688
s_cmp_eq_u32 s48, s50
s_cselect_b32 s48, s28, s48
s_cselect_b32 s49, s29, s49
s_waitcnt lgkmcnt(6)
v_mfma_f32_32x32x16_bf16 v[64:79], v[16:19], v[48:51], v[64:79]
ds_read_b128 v[52:55], v9 offset:32768
ds_read_b64_tr_b16 v[32:33], v4 offset:45056
ds_read_b64_tr_b16 v[34:35], v4 offset:46080
s_waitcnt lgkmcnt(7)
v_mfma_f32_32x32x16_bf16 v[80:95], v[20:23], v[48:51], v[80:95]
ds_read_b64_tr_b16 v[36:37], v5 offset:45056
ds_read_b64_tr_b16 v[38:39], v5 offset:46080
ds_read_b64_tr_b16 v[40:41], v6 offset:45056
v_mfma_f32_16x16x32_bf16 v[160:163], v[164:167], v[16:19], v[160:163]
s_waitcnt lgkmcnt(8)
v_mfma_f32_32x32x16_bf16 v[96:111], v[24:27], v[48:51], v[96:111]
ds_read_b64_tr_b16 v[42:43], v6 offset:46080
ds_read_b64_tr_b16 v[44:45], v7 offset:45056
ds_read_b64_tr_b16 v[46:47], v7 offset:46080
s_waitcnt lgkmcnt(9)
v_mfma_f32_32x32x16_bf16 v[112:127], v[28:31], v[48:51], v[112:127]
s_waitcnt vmcnt(12) lgkmcnt(0)
s_barrier
v_mfma_f32_32x32x16_bf16 v[64:79], v[32:35], v[52:55], v[64:79]
ds_read_b128 v[48:51], v8 offset:49152
ds_read_b64_tr_b16 v[16:17], v4 offset:57344
ds_read_b64_tr_b16 v[18:19], v4 offset:58368
s_add_u32 m0, s30, 32768
s_nop 0
buffer_load_dwordx4 v10, s[4:7], s48 offen lds
v_mfma_f32_32x32x16_bf16 v[80:95], v[36:39], v[52:55], v[80:95]
ds_read_b64_tr_b16 v[20:21], v5 offset:57344
ds_read_b64_tr_b16 v[22:23], v5 offset:58368
ds_read_b64_tr_b16 v[24:25], v6 offset:57344
s_add_u32 m0, s30, 33792
v_mfma_f32_16x16x32_bf16 v[160:163], v[164:167], v[32:35], v[160:163]
buffer_load_dwordx4 v138, s[4:7], s48 offen lds
s_add_u32 s48, s48, 64
v_mfma_f32_32x32x16_bf16 v[96:111], v[40:43], v[52:55], v[96:111]
ds_read_b64_tr_b16 v[26:27], v6 offset:58368
ds_read_b64_tr_b16 v[28:29], v7 offset:57344
ds_read_b64_tr_b16 v[30:31], v7 offset:58368
s_add_u32 m0, s30, 40960
s_nop 0
buffer_load_dwordx4 v11, s[8:11], s49 offen lds
v_mfma_f32_32x32x16_bf16 v[112:127], v[44:47], v[52:55], v[112:127]
s_add_u32 m0, s30, 41984
s_nop 0
buffer_load_dwordx4 v139, s[8:11], s49 offen lds
s_add_u32 s49, s49, 114688
s_cmp_eq_u32 s48, s50
s_cselect_b32 s48, s28, s48
s_cselect_b32 s49, s29, s49
s_waitcnt lgkmcnt(6)
v_mfma_f32_32x32x16_bf16 v[64:79], v[16:19], v[48:51], v[64:79]
ds_read_b128 v[52:55], v9 offset:49152
ds_read_b64_tr_b16 v[32:33], v4 offset:61440
ds_read_b64_tr_b16 v[34:35], v4 offset:62464
s_waitcnt lgkmcnt(7)
v_mfma_f32_32x32x16_bf16 v[80:95], v[20:23], v[48:51], v[80:95]
ds_read_b64_tr_b16 v[36:37], v5 offset:61440
ds_read_b64_tr_b16 v[38:39], v5 offset:62464
ds_read_b64_tr_b16 v[40:41], v6 offset:61440
v_mfma_f32_16x16x32_bf16 v[160:163], v[164:167], v[16:19], v[160:163]
s_waitcnt lgkmcnt(8)
v_mfma_f32_32x32x16_bf16 v[96:111], v[24:27], v[48:51], v[96:111]
ds_read_b64_tr_b16 v[42:43], v6 offset:62464
ds_read_b64_tr_b16 v[44:45], v7 offset:61440
ds_read_b64_tr_b16 v[46:47], v7 offset:62464
s_waitcnt lgkmcnt(9)
v_mfma_f32_32x32x16_bf16 v[112:127], v[28:31], v[48:51], v[112:127]
s_waitcnt vmcnt(12) lgkmcnt(0)
s_barrier
v_mfma_f32_32x32x16_bf16 v[64:79], v[32:35], v[52:55], v[64:79]
ds_read_b128 v[48:51], v136 offset:0
ds_read_b64_tr_b16 v[16:17], v132 offset:8192
ds_read_b64_tr_b16 v[18:19], v132 offset:9216
s_add_u32 m0, s30, 49152
s_nop 0
buffer_load_dwordx4 v10, s[4:7], s48 offen lds
v_mfma_f32_32x32x16_bf16 v[80:95], v[36:39], v[52:55], v[80:95]
ds_read_b64_tr_b16 v[20:21], v133 offset:8192
ds_read_b64_tr_b16 v[22:23], v133 offset:9216
ds_read_b64_tr_b16 v[24:25], v134 offset:8192
s_add_u32 m0, s30, 50176
v_mfma_f32_16x16x32_bf16 v[160:163], v[164:167], v[32:35], v[160:163]
buffer_load_dwordx4 v138, s[4:7], s48 offen lds
s_add_u32 s48, s48, 64
v_mfma_f32_32x32x16_bf16 v[96:111], v[40:43], v[52:55], v[96:111]
ds_read_b64_tr_b16 v[26:27], v134 offset:9216
ds_read_b64_tr_b16 v[28:29], v135 offset:8192
ds_read_b64_tr_b16 v[30:31], v135 offset:9216
s_add_u32 m0, s30, 57344
s_nop 0
buffer_load_dwordx4 v11, s[8:11], s49 offen lds
v_mfma_f32_32x32x16_bf16 v[112:127], v[44:47], v[52:55], v[112:127]
s_add_u32 m0, s30, 58368
s_nop 0
buffer_load_dwordx4 v139, s[8:11], s49 offen lds
s_add_u32 s49, s49, 114688
s_cmp_eq_u32 s48, s50
s_cselect_b32 s48, s28, s48
s_cselect_b32 s49, s29, s49
s_waitcnt lgkmcnt(6)
v_mfma_f32_32x32x16_bf16 v[64:79], v[16:19], v[48:51], v[64:79]
ds_read_b128 v[52:55], v137 offset:0
ds_read_b64_tr_b16 v[32:33], v132 offset:12288
ds_read_b64_tr_b16 v[34:35], v132 offset:13312
s_waitcnt lgkmcnt(7)
v_mfma_f32_32x32x16_bf16 v[80:95], v[20:23], v[48:51], v[80:95]
ds_read_b64_tr_b16 v[36:37], v133 offset:12288
ds_read_b64_tr_b16 v[38:39], v133 offset:13312
ds_read_b64_tr_b16 v[40:41], v134 offset:12288
v_mfma_f32_16x16x32_bf16 v[160:163], v[164:167], v[16:19], v[160:163]
s_waitcnt lgkmcnt(8)
v_mfma_f32_32x32x16_bf16 v[96:111], v[24:27], v[48:51], v[96:111]
ds_read_b64_tr_b16 v[42:43], v134 offset:13312
ds_read_b64_tr_b16 v[44:45], v135 offset:12288
ds_read_b64_tr_b16 v[46:47], v135 offset:13312
s_waitcnt lgkmcnt(9)
v_mfma_f32_32x32x16_bf16 v[112:127], v[28:31], v[48:51], v[112:127]
s_waitcnt vmcnt(12) lgkmcnt(0)
s_barrier
v_mfma_f32_32x32x16_bf16 v[64:79], v[32:35], v[52:55], v[64:79]
ds_read_b128 v[48:51], v8 offset:0
ds_read_b64_tr_b16 v[16:17], v4 offset:8192
ds_read_b64_tr_b16 v[18:19], v4 offset:9216
s_add_u32 m0, s30, 65536
s_nop 0
buffer_load_dwordx4 v10, s[4:7], s48 offen lds
v_mfma_f32_32x32x16_bf16 v[80:95], v[36:39], v[52:55], v[80:95]
ds_read_b64_tr_b16 v[20:21], v5 offset:8192
ds_read_b64_tr_b16 v[22:23], v5 offset:9216
ds_read_b64_tr_b16 v[24:25], v6 offset:8192
s_add_u32 m0, s30, 66560
v_mfma_f32_16x16x32_bf16 v[160:163], v[164:167], v[32:35], v[160:163]
buffer_load_dwordx4 v138, s[4:7], s48 offen lds
s_add_u32 s48, s48, 64
v_mfma_f32_32x32x16_bf16 v[96:111], v[40:43], v[52:55], v[96:111]
ds_read_b64_tr_b16 v[26:27], v6 offset:9216
ds_read_b64_tr_b16 v[28:29], v7 offset:8192
ds_read_b64_tr_b16 v[30:31], v7 offset:9216
s_add_u32 m0, s30, 73728
s_nop 0
buffer_load_dwordx4 v11, s[8:11], s49 offen lds
v_mfma_f32_32x32x16_bf16 v[112:127], v[44:47], v[52:55], v[112:127]
s_add_u32 m0, s30, 74752
s_nop 0
buffer_load_dwordx4 v139, s[8:11], s49 offen lds
s_add_u32 s49, s49, 114688
s_cmp_eq_u32 s48, s50
s_cselect_b32 s48, s28, s48
s_cselect_b32 s49, s29, s49
s_waitcnt lgkmcnt(6)
v_mfma_f32_32x32x16_bf16 v[64:79], v[16:19], v[48:51], v[64:79]
ds_read_b128 v[52:55], v9 offset:0
ds_read_b64_tr_b16 v[32:33], v4 offset:12288
ds_read_b64_tr_b16 v[34:35], v4 offset:13312
s_waitcnt lgkmcnt(7)
v_mfma_f32_32x32x16_bf16 v[80:95], v[20:23], v[48:51], v[80:95]
ds_read_b64_tr_b16 v[36:37], v5 offset:12288
ds_read_b64_tr_b16 v[38:39], v5 offset:13312
ds_read_b64_tr_b16 v[40:41], v6 offset:12288
v_mfma_f32_16x16x32_bf16 v[160:163], v[164:167], v[16:19], v[160:163]
s_waitcnt lgkmcnt(8)
v_mfma_f32_32x32x16_bf16 v[96:111], v[24:27], v[48:51], v[96:111]
ds_read_b64_tr_b16 v[42:43], v6 offset:13312
ds_read_b64_tr_b16 v[44:45], v7 offset:12288
ds_read_b64_tr_b16 v[46:47], v7 offset:13312
s_waitcnt lgkmcnt(9)
v_mfma_f32_32x32x16_bf16 v[112:127], v[28:31], v[48:51], v[112:127]
s_waitcnt vmcnt(12) lgkmcnt(0)
s_barrier
v_mfma_f32_32x32x16_bf16 v[64:79], v[32:35], v[52:55], v[64:79]
ds_read_b128 v[48:51], v8 offset:16384
ds_read_b64_tr_b16 v[16:17], v4 offset:24576
ds_read_b64_tr_b16 v[18:19], v4 offset:25600
s_add_u32 m0, s30, 0
s_nop 0
buffer_load_dwordx4 v10, s[4:7], s48 offen lds
v_mfma_f32_32x32x16_bf16 v[80:95], v[36:39], v[52:55], v[80:95]
ds_read_b64_tr_b16 v[20:21], v5 offset:24576
ds_read_b64_tr_b16 v[22:23], v5 offset:25600
ds_read_b64_tr_b16 v[24:25], v6 offset:24576
s_add_u32 m0, s30, 1024
v_mfma_f32_16x16x32_bf16 v[160:163], v[164:167], v[32:35], v[160:163]
buffer_load_dwordx4 v138, s[4:7], s48 offen lds
s_add_u32 s48, s48, 64
v_mfma_f32_32x32x16_bf16 v[96:111], v[40:43], v[52:55], v[96:111]
ds_read_b64_tr_b16 v[26:27], v6 offset:25600
ds_read_b64_tr_b16 v[28:29], v7 offset:24576
ds_read_b64_tr_b16 v[30:31], v7 offset:25600
s_add_u32 m0, s30, 8192
s_nop 0
buffer_load_dwordx4 v11, s[8:11], s49 offen lds
v_mfma_f32_32x32x16_bf16 v[112:127], v[44:47], v[52:55], v[112:127]
s_add_u32 m0, s30, 9216
s_nop 0
buffer_load_dwordx4 v139, s[8:11], s49 offen lds
s_add_u32 s49, s49, 114688
s_cmp_eq_u32 s48, s50
s_cselect_b32 s48, s28, s48
s_cselect_b32 s49, s29, s49
s_waitcnt lgkmcnt(6)
v_mfma_f32_32x32x16_bf16 v[64:79], v[16:19], v[48:51], v[64:79]
ds_read_b128 v[52:55], v9 offset:16384
ds_read_b64_tr_b16 v[32:33], v4 offset:28672
ds_read_b64_tr_b16 v[34:35], v4 offset:29696
s_waitcnt lgkmcnt(7)
v_mfma_f32_32x32x16_bf16 v[80:95], v[20:23], v[48:51], v[80:95]
ds_read_b64_tr_b16 v[36:37], v5 offset:28672
ds_read_b64_tr_b16 v[38:39], v5 offset:29696
ds_read_b64_tr_b16 v[40:41], v6 offset:28672
v_mfma_f32_16x16x32_bf16 v[160:163], v[164:167], v[16:19], v[160:163]
s_waitcnt lgkmcnt(8)
v_mfma_f32_32x32x16_bf16 v[96:111], v[24:27], v[48:51], v[96:111]
ds_read_b64_tr_b16 v[42:43], v6 offset:29696
ds_read_b64_tr_b16 v[44:45], v7 offset:28672
ds_read_b64_tr_b16 v[46:47], v7 offset:29696
s_waitcnt lgkmcnt(9)
v_mfma_f32_32x32x16_bf16 v[112:127], v[28:31], v[48:51], v[112:127]
s_waitcnt vmcnt(12) lgkmcnt(0)
s_barrier
v_mfma_f32_32x32x16_bf16 v[64:79], v[32:35], v[52:55], v[64:79]
ds_read_b128 v[48:51], v8 offset:32768
ds_read_b64_tr_b16 v[16:17], v4 offset:40960
ds_read_b64_tr_b16 v[18:19], v4 offset:41984
s_add_u32 m0, s30, 16384
s_nop 0
buffer_load_dwordx4 v10, s[4:7], s48 offen lds
v_mfma_f32_32x32x16_bf16 v[80:95], v[36:39], v[52:55], v[80:95]
ds_read_b64_tr_b16 v[20:21], v5 offset:40960
ds_read_b64_tr_b16 v[22:23], v5 offset:41984
ds_read_b64_tr_b16 v[24:25], v6 offset:40960
s_add_u32 m0, s30, 17408
v_mfma_f32_16x16x32_bf16 v[160:163], v[164:167], v[32:35], v[160:163]
buffer_load_dwordx4 v138, s[4:7], s48 offen lds
s_add_u32 s48, s48, 64
v_mfma_f32_32x32x16_bf16 v[96:111], v[40:43], v[52:55], v[96:111]
ds_read_b64_tr_b16 v[26:27], v6 offset:41984
ds_read_b64_tr_b16 v[28:29], v7 offset:40960
ds_read_b64_tr_b16 v[30:31], v7 offset:41984
s_add_u32 m0, s30, 24576
s_nop 0
buffer_load_dwordx4 v11, s[8:11], s49 offen lds
v_mfma_f32_32x32x16_bf16 v[112:127], v[44:47], v[52:55], v[112:127]
s_add_u32 m0, s30, 25600
s_nop 0
buffer_load_dwordx4 v139, s[8:11], s49 offen lds
s_add_u32 s49, s49, 114688
s_cmp_eq_u32 s48, s50
s_cselect_b32 s48, s28, s48
s_cselect_b32 s49, s29, s49
s_waitcnt lgkmcnt(6)
v_mfma_f32_32x32x16_bf16 v[64:79], v[16:19], v[48:51], v[64:79]
ds_read_b128 v[52:55], v9 offset:32768
ds_read_b64_tr_b16 v[32:33], v4 offset:45056
ds_read_b64_tr_b16 v[34:35], v4 offset:46080
s_waitcnt lgkmcnt(7)
v_mfma_f32_32x32x16_bf16 v[80:95], v[20:23], v[48:51], v[80:95]
ds_read_b64_tr_b16 v[36:37], v5 offset:45056
ds_read_b64_tr_b16 v[38:39], v5 offset:46080
ds_read_b64_tr_b16 v[40:41], v6 offset:45056
v_mfma_f32_16x16x32_bf16 v[160:163], v[164:167], v[16:19], v[160:163]
s_waitcnt lgkmcnt(8)
v_mfma_f32_32x32x16_bf16 v[96:111], v[24:27], v[48:51], v[96:111]
ds_read_b64_tr_b16 v[42:43], v6 offset:46080
ds_read_b64_tr_b16 v[44:45], v7 offset:45056
ds_read_b64_tr_b16 v[46:47], v7 offset:46080
s_waitcnt lgkmcnt(9)
v_mfma_f32_32x32x16_bf16 v[112:127], v[28:31], v[48:51], v[112:127]
s_waitcnt vmcnt(12) lgkmcnt(0)
s_barrier
v_mfma_f32_32x32x16_bf16 v[64:79], v[32:35], v[52:55], v[64:79]
ds_read_b128 v[48:51], v8 offset:49152
ds_read_b64_tr_b16 v[16:17], v4 offset:57344
ds_read_b64_tr_b16 v[18:19], v4 offset:58368
s_add_u32 m0, s30, 32768
s_nop 0
buffer_load_dwordx4 v10, s[4:7], s48 offen lds
v_mfma_f32_32x32x16_bf16 v[80:95], v[36:39], v[52:55], v[80:95]
ds_read_b64_tr_b16 v[20:21], v5 offset:57344
ds_read_b64_tr_b16 v[22:23], v5 offset:58368
ds_read_b64_tr_b16 v[24:25], v6 offset:57344
s_add_u32 m0, s30, 33792
v_mfma_f32_16x16x32_bf16 v[160:163], v[164:167], v[32:35], v[160:163]
buffer_load_dwordx4 v138, s[4:7], s48 offen lds
s_add_u32 s48, s48, 64
v_mfma_f32_32x32x16_bf16 v[96:111], v[40:43], v[52:55], v[96:111]
ds_read_b64_tr_b16 v[26:27], v6 offset:58368
ds_read_b64_tr_b16 v[28:29], v7 offset:57344
ds_read_b64_tr_b16 v[30:31], v7 offset:58368
s_add_u32 m0, s30, 40960
s_nop 0
buffer_load_dwordx4 v11, s[8:11], s49 offen lds
v_mfma_f32_32x32x16_bf16 v[112:127], v[44:47], v[52:55], v[112:127]
s_add_u32 m0, s30, 41984
s_nop 0
buffer_load_dwordx4 v139, s[8:11], s49 offen lds
s_add_u32 s49, s49, 114688
s_cmp_eq_u32 s48, s50
s_cselect_b32 s48, s28, s48
s_cselect_b32 s49, s29, s49
s_waitcnt lgkmcnt(6)
v_mfma_f32_32x32x16_bf16 v[64:79], v[16:19], v[48:51], v[64:79]
ds_read_b128 v[52:55], v9 offset:49152
ds_read_b64_tr_b16 v[32:33], v4 offset:61440
ds_read_b64_tr_b16 v[34:35], v4 offset:62464
s_waitcnt lgkmcnt(7)
v_mfma_f32_32x32x16_bf16 v[80:95], v[20:23], v[48:51], v[80:95]
ds_read_b64_tr_b16 v[36:37], v5 offset:61440
ds_read_b64_tr_b16 v[38:39], v5 offset:62464
ds_read_b64_tr_b16 v[40:41], v6 offset:61440
v_mfma_f32_16x16x32_bf16 v[160:163], v[164:167], v[16:19], v[160:163]
s_waitcnt lgkmcnt(8)
v_mfma_f32_32x32x16_bf16 v[96:111], v[24:27], v[48:51], v[96:111]
ds_read_b64_tr_b16 v[42:43], v6 offset:62464
ds_read_b64_tr_b16 v[44:45], v7 offset:61440
ds_read_b64_tr_b16 v[46:47], v7 offset:62464
s_waitcnt lgkmcnt(9)
v_mfma_f32_32x32x16_bf16 v[112:127], v[28:31], v[48:51], v[112:127]
s_waitcnt vmcnt(12) lgkmcnt(0)
s_barrier
v_mfma_f32_32x32x16_bf16 v[64:79], v[32:35], v[52:55], v[64:79]
ds_read_b128 v[48:51], v136 offset:0
ds_read_b64_tr_b16 v[16:17], v132 offset:8192
ds_read_b64_tr_b16 v[18:19], v132 offset:9216
s_add_u32 m0, s30, 49152
s_nop 0
buffer_load_dwordx4 v10, s[4:7], s48 offen lds
v_mfma_f32_32x32x16_bf16 v[80:95], v[36:39], v[52:55], v[80:95]
ds_read_b64_tr_b16 v[20:21], v133 offset:8192
ds_read_b64_tr_b16 v[22:23], v133 offset:9216
ds_read_b64_tr_b16 v[24:25], v134 offset:8192
s_add_u32 m0, s30, 50176
v_mfma_f32_16x16x32_bf16 v[160:163], v[164:167], v[32:35], v[160:163]
buffer_load_dwordx4 v138, s[4:7], s48 offen lds
s_add_u32 s48, s48, 64
v_mfma_f32_32x32x16_bf16 v[96:111], v[40:43], v[52:55], v[96:111]
ds_read_b64_tr_b16 v[26:27], v134 offset:9216
ds_read_b64_tr_b16 v[28:29], v135 offset:8192
ds_read_b64_tr_b16 v[30:31], v135 offset:9216
s_add_u32 m0, s30, 57344
s_nop 0
buffer_load_dwordx4 v11, s[8:11], s49 offen lds
v_mfma_f32_32x32x16_bf16 v[112:127], v[44:47], v[52:55], v[112:127]
s_add_u32 m0, s30, 58368
s_nop 0
buffer_load_dwordx4 v139, s[8:11], s49 offen lds
s_add_u32 s49, s49, 114688
s_cmp_eq_u32 s48, s50
s_cselect_b32 s48, s28, s48
s_cselect_b32 s49, s29, s49
s_add_u32 s44, s42, 16777216
s_addc_u32 s45, s43, 0
s_mov_b32 s46, 65536
s_mov_b32 s47, 0x20000
v_mov_b32 v131, 0
global_load_dword v130, v131, s[62:63] sc1
v_and_b32 v141, 31, v2
v_lshlrev_b32 v141, 3, v141
s_lshl_b32 s51, s25, 10
s_lshl_b32 s52, s24, 8
s_add_u32 s51, s51, s52
s_add_u32 s51, s51, 49152
buffer_load_dwordx2 v[142:143], v141, s[44:47], s51 offen sc1

s_waitcnt lgkmcnt(6)
v_mfma_f32_32x32x16_bf16 v[64:79], v[16:19], v[48:51], v[64:79]
ds_read_b128 v[52:55], v137 offset:0
ds_read_b64_tr_b16 v[32:33], v132 offset:12288
ds_read_b64_tr_b16 v[34:35], v132 offset:13312
s_waitcnt lgkmcnt(7)
v_mfma_f32_32x32x16_bf16 v[80:95], v[20:23], v[48:51], v[80:95]
ds_read_b64_tr_b16 v[36:37], v133 offset:12288
ds_read_b64_tr_b16 v[38:39], v133 offset:13312
ds_read_b64_tr_b16 v[40:41], v134 offset:12288
v_mfma_f32_16x16x32_bf16 v[160:163], v[164:167], v[16:19], v[160:163]
s_waitcnt lgkmcnt(8)
v_mfma_f32_32x32x16_bf16 v[96:111], v[24:27], v[48:51], v[96:111]
ds_read_b64_tr_b16 v[42:43], v134 offset:13312
ds_read_b64_tr_b16 v[44:45], v135 offset:12288
ds_read_b64_tr_b16 v[46:47], v135 offset:13312
s_waitcnt lgkmcnt(9)
v_mfma_f32_32x32x16_bf16 v[112:127], v[28:31], v[48:51], v[112:127]
s_waitcnt vmcnt(14) lgkmcnt(0)
s_barrier
v_mfma_f32_32x32x16_bf16 v[64:79], v[32:35], v[52:55], v[64:79]
ds_read_b128 v[48:51], v8 offset:0
ds_read_b64_tr_b16 v[16:17], v4 offset:8192
ds_read_b64_tr_b16 v[18:19], v4 offset:9216
v_mfma_f32_32x32x16_bf16 v[80:95], v[36:39], v[52:55], v[80:95]
ds_read_b64_tr_b16 v[20:21], v5 offset:8192
ds_read_b64_tr_b16 v[22:23], v5 offset:9216
ds_read_b64_tr_b16 v[24:25], v6 offset:8192
v_mfma_f32_16x16x32_bf16 v[160:163], v[164:167], v[32:35], v[160:163]
v_mfma_f32_32x32x16_bf16 v[96:111], v[40:43], v[52:55], v[96:111]
ds_read_b64_tr_b16 v[26:27], v6 offset:9216
ds_read_b64_tr_b16 v[28:29], v7 offset:8192
ds_read_b64_tr_b16 v[30:31], v7 offset:9216
v_mfma_f32_32x32x16_bf16 v[112:127], v[44:47], v[52:55], v[112:127]
s_waitcnt lgkmcnt(6)
v_mfma_f32_32x32x16_bf16 v[64:79], v[16:19], v[48:51], v[64:79]
ds_read_b128 v[52:55], v9 offset:0
ds_read_b64_tr_b16 v[32:33], v4 offset:12288
ds_read_b64_tr_b16 v[34:35], v4 offset:13312
s_waitcnt lgkmcnt(7)
v_mfma_f32_32x32x16_bf16 v[80:95], v[20:23], v[48:51], v[80:95]
ds_read_b64_tr_b16 v[36:37], v5 offset:12288
ds_read_b64_tr_b16 v[38:39], v5 offset:13312
ds_read_b64_tr_b16 v[40:41], v6 offset:12288
v_mfma_f32_16x16x32_bf16 v[160:163], v[164:167], v[16:19], v[160:163]
s_waitcnt lgkmcnt(8)
v_mfma_f32_32x32x16_bf16 v[96:111], v[24:27], v[48:51], v[96:111]
ds_read_b64_tr_b16 v[42:43], v6 offset:13312
ds_read_b64_tr_b16 v[44:45], v7 offset:12288
ds_read_b64_tr_b16 v[46:47], v7 offset:13312
s_waitcnt lgkmcnt(9)
v_mfma_f32_32x32x16_bf16 v[112:127], v[28:31], v[48:51], v[112:127]
s_waitcnt vmcnt(10) lgkmcnt(0)
s_barrier
v_mfma_f32_32x32x16_bf16 v[64:79], v[32:35], v[52:55], v[64:79]
ds_read_b128 v[48:51], v8 offset:16384
ds_read_b64_tr_b16 v[16:17], v4 offset:24576
ds_read_b64_tr_b16 v[18:19], v4 offset:25600
v_mfma_f32_32x32x16_bf16 v[80:95], v[36:39], v[52:55], v[80:95]
ds_read_b64_tr_b16 v[20:21], v5 offset:24576
ds_read_b64_tr_b16 v[22:23], v5 offset:25600
ds_read_b64_tr_b16 v[24:25], v6 offset:24576
v_mfma_f32_16x16x32_bf16 v[160:163], v[164:167], v[32:35], v[160:163]
v_mfma_f32_32x32x16_bf16 v[96:111], v[40:43], v[52:55], v[96:111]
ds_read_b64_tr_b16 v[26:27], v6 offset:25600
ds_read_b64_tr_b16 v[28:29], v7 offset:24576
ds_read_b64_tr_b16 v[30:31], v7 offset:25600
v_mfma_f32_32x32x16_bf16 v[112:127], v[44:47], v[52:55], v[112:127]
s_waitcnt lgkmcnt(6)
v_mfma_f32_32x32x16_bf16 v[64:79], v[16:19], v[48:51], v[64:79]
ds_read_b128 v[52:55], v9 offset:16384
ds_read_b64_tr_b16 v[32:33], v4 offset:28672
ds_read_b64_tr_b16 v[34:35], v4 offset:29696
s_waitcnt lgkmcnt(7)
v_mfma_f32_32x32x16_bf16 v[80:95], v[20:23], v[48:51], v[80:95]
ds_read_b64_tr_b16 v[36:37], v5 offset:28672
ds_read_b64_tr_b16 v[38:39], v5 offset:29696
ds_read_b64_tr_b16 v[40:41], v6 offset:28672
v_mfma_f32_16x16x32_bf16 v[160:163], v[164:167], v[16:19], v[160:163]
s_waitcnt lgkmcnt(8)
v_mfma_f32_32x32x16_bf16 v[96:111], v[24:27], v[48:51], v[96:111]
ds_read_b64_tr_b16 v[42:43], v6 offset:29696
ds_read_b64_tr_b16 v[44:45], v7 offset:28672
ds_read_b64_tr_b16 v[46:47], v7 offset:29696
s_waitcnt lgkmcnt(9)
v_mfma_f32_32x32x16_bf16 v[112:127], v[28:31], v[48:51], v[112:127]
s_waitcnt vmcnt(6) lgkmcnt(0)
s_barrier
v_mfma_f32_32x32x16_bf16 v[64:79], v[32:35], v[52:55], v[64:79]
ds_read_b128 v[48:51], v8 offset:32768
ds_read_b64_tr_b16 v[16:17], v4 offset:40960
ds_read_b64_tr_b16 v[18:19], v4 offset:41984
v_mfma_f32_32x32x16_bf16 v[80:95], v[36:39], v[52:55], v[80:95]
ds_read_b64_tr_b16 v[20:21], v5 offset:40960
ds_read_b64_tr_b16 v[22:23], v5 offset:41984
ds_read_b64_tr_b16 v[24:25], v6 offset:40960
v_mfma_f32_16x16x32_bf16 v[160:163], v[164:167], v[32:35], v[160:163]
v_mfma_f32_32x32x16_bf16 v[96:111], v[40:43], v[52:55], v[96:111]
ds_read_b64_tr_b16 v[26:27], v6 offset:41984
ds_read_b64_tr_b16 v[28:29], v7 offset:40960
ds_read_b64_tr_b16 v[30:31], v7 offset:41984
v_mfma_f32_32x32x16_bf16 v[112:127], v[44:47], v[52:55], v[112:127]
s_waitcnt lgkmcnt(6)
v_mfma_f32_32x32x16_bf16 v[64:79], v[16:19], v[48:51], v[64:79]
ds_read_b128 v[52:55], v9 offset:32768
ds_read_b64_tr_b16 v[32:33], v4 offset:45056
ds_read_b64_tr_b16 v[34:35], v4 offset:46080
s_waitcnt lgkmcnt(7)
v_mfma_f32_32x32x16_bf16 v[80:95], v[20:23], v[48:51], v[80:95]
ds_read_b64_tr_b16 v[36:37], v5 offset:45056
ds_read_b64_tr_b16 v[38:39], v5 offset:46080
ds_read_b64_tr_b16 v[40:41], v6 offset:45056
v_mfma_f32_16x16x32_bf16 v[160:163], v[164:167], v[16:19], v[160:163]
s_waitcnt lgkmcnt(8)
v_mfma_f32_32x32x16_bf16 v[96:111], v[24:27], v[48:51], v[96:111]
ds_read_b64_tr_b16 v[42:43], v6 offset:46080
ds_read_b64_tr_b16 v[44:45], v7 offset:45056
ds_read_b64_tr_b16 v[46:47], v7 offset:46080
s_waitcnt lgkmcnt(9)
v_mfma_f32_32x32x16_bf16 v[112:127], v[28:31], v[48:51], v[112:127]
s_waitcnt vmcnt(2) lgkmcnt(0)
s_barrier
v_mfma_f32_32x32x16_bf16 v[64:79], v[32:35], v[52:55], v[64:79]
ds_read_b128 v[48:51], v8 offset:49152
ds_read_b64_tr_b16 v[16:17], v4 offset:57344
ds_read_b64_tr_b16 v[18:19], v4 offset:58368
v_mfma_f32_32x32x16_bf16 v[80:95], v[36:39], v[52:55], v[80:95]
ds_read_b64_tr_b16 v[20:21], v5 offset:57344
ds_read_b64_tr_b16 v[22:23], v5 offset:58368
ds_read_b64_tr_b16 v[24:25], v6 offset:57344
v_mfma_f32_16x16x32_bf16 v[160:163], v[164:167], v[32:35], v[160:163]
v_mfma_f32_32x32x16_bf16 v[96:111], v[40:43], v[52:55], v[96:111]
ds_read_b64_tr_b16 v[26:27], v6 offset:58368
ds_read_b64_tr_b16 v[28:29], v7 offset:57344
ds_read_b64_tr_b16 v[30:31], v7 offset:58368
v_mfma_f32_32x32x16_bf16 v[112:127], v[44:47], v[52:55], v[112:127]
s_waitcnt lgkmcnt(6)
v_mfma_f32_32x32x16_bf16 v[64:79], v[16:19], v[48:51], v[64:79]
ds_read_b128 v[52:55], v9 offset:49152
ds_read_b64_tr_b16 v[32:33], v4 offset:61440
ds_read_b64_tr_b16 v[34:35], v4 offset:62464
s_waitcnt lgkmcnt(7)
v_mfma_f32_32x32x16_bf16 v[80:95], v[20:23], v[48:51], v[80:95]
ds_read_b64_tr_b16 v[36:37], v5 offset:61440
ds_read_b64_tr_b16 v[38:39], v5 offset:62464
ds_read_b64_tr_b16 v[40:41], v6 offset:61440
v_mfma_f32_16x16x32_bf16 v[160:163], v[164:167], v[16:19], v[160:163]
s_waitcnt lgkmcnt(8)
v_mfma_f32_32x32x16_bf16 v[96:111], v[24:27], v[48:51], v[96:111]
ds_read_b64_tr_b16 v[42:43], v6 offset:62464
ds_read_b64_tr_b16 v[44:45], v7 offset:61440
ds_read_b64_tr_b16 v[46:47], v7 offset:62464
s_waitcnt lgkmcnt(9)
v_mfma_f32_32x32x16_bf16 v[112:127], v[28:31], v[48:51], v[112:127]
s_waitcnt lgkmcnt(6)
v_mfma_f32_32x32x16_bf16 v[64:79], v[32:35], v[52:55], v[64:79]
s_waitcnt lgkmcnt(4)
v_mfma_f32_32x32x16_bf16 v[80:95], v[36:39], v[52:55], v[80:95]
v_mfma_f32_16x16x32_bf16 v[160:163], v[164:167], v[32:35], v[160:163]
s_waitcnt lgkmcnt(2)
v_mfma_f32_32x32x16_bf16 v[96:111], v[40:43], v[52:55], v[96:111]
s_waitcnt lgkmcnt(0)
v_mfma_f32_32x32x16_bf16 v[112:127], v[44:47], v[52:55], v[112:127]
s_waitcnt vmcnt(0)
v_readfirstlane_b32 s69, v130
s_mov_b32 s61, 20000
s_nop 1
s_cmp_lg_u32 s69, 0
s_cbranch_scc1 L_nf_5_d
L_nf_5:
global_load_dword v130, v131, s[62:63] sc1
s_waitcnt vmcnt(0)
v_readfirstlane_b32 s69, v130
s_sub_u32 s61, s61, 1
s_cbranch_scc1 L_nf_5_d
s_cmp_eq_u32 s69, 0
s_cbranch_scc1 L_nf_5
L_nf_5_d:

v_cmp_ne_u32 vcc, s69, v142
s_cbranch_vccz L_gr_6_d
s_mov_b32 s61, 20000
L_gr_6:
buffer_load_dwordx2 v[142:143], v141, s[44:47], s51 offen sc1
s_sub_u32 s61, s61, 1
s_cbranch_scc1 L_gr_6_d
s_waitcnt vmcnt(0)
v_cmp_ne_u32 vcc, s69, v142
s_cbranch_vccnz L_gr_6
L_gr_6_d:

s_nop 7
v_and_b32 v56, 31, v2
v_lshlrev_b32 v56, 2, v56
s_lshl_b32 s31, s24, 7
s_add_u32 s31, s31, 65536
v_add_u32 v56, s31, v56
v_lshlrev_b32 v12, 16, v143
v_and_b32 v13, 0xffff0000, v143
s_nop 4
ds_write_b32 v56, v160
v_rcp_f32 v14, v13
s_waitcnt lgkmcnt(0)
s_barrier

v_and_b32 v56, 31, v2
v_lshlrev_b32 v56, 2, v56
s_add_u32 s32, s24, 0
s_and_b32 s32, s32, 3
s_lshl_b32 s32, s32, 7
s_add_u32 s32, s32, 65536
v_add_u32 v57, s32, v56
ds_read_b32 v16, v57

s_add_u32 s32, s24, 1
s_and_b32 s32, s32, 3
s_lshl_b32 s32, s32, 7
s_add_u32 s32, s32, 65536
v_add_u32 v57, s32, v56
ds_read_b32 v20, v57

s_add_u32 s32, s24, 2
s_and_b32 s32, s32, 3
s_lshl_b32 s32, s32, 7
s_add_u32 s32, s32, 65536
v_add_u32 v57, s32, v56
ds_read_b32 v24, v57

s_add_u32 s32, s24, 3
s_and_b32 s32, s32, 3
s_lshl_b32 s32, s32, 7
s_add_u32 s32, s32, 65536
v_add_u32 v57, s32, v56
ds_read_b32 v28, v57

v_sub_f32 v32, 0, v12
v_cvt_pk_bf16_f32 v48, v32, v32
v_lshrrev_b32 v49, 16, v13
v_mov_b32 v50, 0
v_mov_b32 v51, 0
v_cmp_gt_u32 vcc, 32, v2
s_nop 1
v_cndmask_b32 v48, 0, v48, vcc
v_cndmask_b32 v49, 0, v49, vcc
s_waitcnt lgkmcnt(0)

v_cvt_pk_bf16_f32 v32, v16, v16
v_lshlrev_b32 v32, 16, v32
v_sub_f32 v33, v16, v32
v_cvt_pk_bf16_f32 v16, v32, v33
v_mov_b32 v17, v60
v_mov_b32 v18, 0
v_mov_b32 v19, 0

v_cvt_pk_bf16_f32 v32, v20, v20
v_lshlrev_b32 v32, 16, v32
v_sub_f32 v33, v20, v32
v_cvt_pk_bf16_f32 v20, v32, v33
v_mov_b32 v21, v61
v_mov_b32 v22, 0
v_mov_b32 v23, 0

v_cvt_pk_bf16_f32 v32, v24, v24
v_lshlrev_b32 v32, 16, v32
v_sub_f32 v33, v24, v32
v_cvt_pk_bf16_f32 v24, v32, v33
v_mov_b32 v25, v62
v_mov_b32 v26, 0
v_mov_b32 v27, 0

v_cvt_pk_bf16_f32 v32, v28, v28
v_lshlrev_b32 v32, 16, v32
v_sub_f32 v33, v28, v32
v_cvt_pk_bf16_f32 v28, v32, v33
v_mov_b32 v29, v63
v_mov_b32 v30, 0
v_mov_b32 v31, 0

s_nop 1
v_mfma_f32_32x32x16_bf16 v[64:79], v[16:19], v[48:51], v[64:79]
v_mfma_f32_32x32x16_bf16 v[80:95], v[20:23], v[48:51], v[80:95]
v_mfma_f32_32x32x16_bf16 v[96:111], v[24:27], v[48:51], v[96:111]
v_mfma_f32_32x32x16_bf16 v[112:127], v[28:31], v[48:51], v[112:127]
v_mul_f32 v59, 1069066811, v14
v_mul_f32 v3, -2.0, v14
v_lshlrev_b32 v1, 4, v2
s_nop 7
s_nop 3

s_lshl_b32 s31, s25, 2
s_add_u32 s31, s31, s24
s_mul_i32 s31, s31, 112
s_lshl_b32 s32, s26, 3
s_add_u32 s31, s31, s32
s_lshl_b32 s33, s31, 10

v_mov_b32 v150, v59
v_mov_b32 v151, v59
v_mov_b32 v152, v3
v_mov_b32 v153, v3
v_mov_b32 v154, v14
v_mov_b32 v155, v14
s_mov_b32 s52, 2.0
s_mov_b32 s53, 2.0
s_add_u32 s32, s24, 0
s_and_b32 s32, s32, 3
s_lshl_b32 s32, s32, 11
s_add_u32 s34, s33, s32

v_pk_mul_f32 v[16:17], v[64:65], v[150:151]
v_pk_mul_f32 v[18:19], v[66:67], v[150:151]
v_pk_mul_f32 v[20:21], v[68:69], v[150:151]
v_pk_mul_f32 v[22:23], v[70:71], v[150:151]
v_exp_f32 v16, v16
v_exp_f32 v17, v17
v_exp_f32 v18, v18
v_exp_f32 v19, v19
v_exp_f32 v20, v20
v_exp_f32 v21, v21
v_exp_f32 v22, v22
v_exp_f32 v23, v23
v_pk_add_f32 v[24:25], v[16:17], s[52:53]
v_pk_add_f32 v[26:27], v[18:19], s[52:53]
v_pk_add_f32 v[28:29], v[20:21], s[52:53]
v_pk_add_f32 v[30:31], v[22:23], s[52:53]
v_pk_fma_f32 v[24:25], v[16:17], v[24:25], s[52:53]
v_pk_fma_f32 v[26:27], v[18:19], v[26:27], s[52:53]
v_pk_fma_f32 v[28:29], v[20:21], v[28:29], s[52:53]
v_pk_fma_f32 v[30:31], v[22:23], v[30:31], s[52:53]
v_rcp_f32 v24, v24
v_rcp_f32 v25, v25
v_rcp_f32 v26, v26
v_rcp_f32 v27, v27
v_rcp_f32 v28, v28
v_rcp_f32 v29, v29
v_rcp_f32 v30, v30
v_rcp_f32 v31, v31
v_pk_fma_f32 v[24:25], v[24:25], v[152:153], v[154:155]
v_pk_fma_f32 v[26:27], v[26:27], v[152:153], v[154:155]
v_pk_fma_f32 v[28:29], v[28:29], v[152:153], v[154:155]
v_pk_fma_f32 v[30:31], v[30:31], v[152:153], v[154:155]
v_pk_mul_f32 v[24:25], v[64:65], v[24:25]
v_pk_mul_f32 v[26:27], v[66:67], v[26:27]
v_pk_mul_f32 v[28:29], v[68:69], v[28:29]
v_pk_mul_f32 v[30:31], v[70:71], v[30:31]
v_cvt_pk_bf16_f32 v40, v24, v25
v_cvt_pk_bf16_f32 v41, v26, v27
v_cvt_pk_bf16_f32 v42, v28, v29
v_cvt_pk_bf16_f32 v43, v30, v31
buffer_store_dwordx4 v[40:43], v1, s[12:15], s34 offen offset:0 sc1
v_pk_mul_f32 v[16:17], v[72:73], v[150:151]
v_pk_mul_f32 v[18:19], v[74:75], v[150:151]
v_pk_mul_f32 v[20:21], v[76:77], v[150:151]
v_pk_mul_f32 v[22:23], v[78:79], v[150:151]
v_exp_f32 v16, v16
v_exp_f32 v17, v17
v_exp_f32 v18, v18
v_exp_f32 v19, v19
v_exp_f32 v20, v20
v_exp_f32 v21, v21
v_exp_f32 v22, v22
v_exp_f32 v23, v23
v_pk_add_f32 v[24:25], v[16:17], s[52:53]
v_pk_add_f32 v[26:27], v[18:19], s[52:53]
v_pk_add_f32 v[28:29], v[20:21], s[52:53]
v_pk_add_f32 v[30:31], v[22:23], s[52:53]
v_pk_fma_f32 v[24:25], v[16:17], v[24:25], s[52:53]
v_pk_fma_f32 v[26:27], v[18:19], v[26:27], s[52:53]
v_pk_fma_f32 v[28:29], v[20:21], v[28:29], s[52:53]
v_pk_fma_f32 v[30:31], v[22:23], v[30:31], s[52:53]
v_rcp_f32 v24, v24
v_rcp_f32 v25, v25
v_rcp_f32 v26, v26
v_rcp_f32 v27, v27
v_rcp_f32 v28, v28
v_rcp_f32 v29, v29
v_rcp_f32 v30, v30
v_rcp_f32 v31, v31
v_pk_fma_f32 v[24:25], v[24:25], v[152:153], v[154:155]
v_pk_fma_f32 v[26:27], v[26:27], v[152:153], v[154:155]
v_pk_fma_f32 v[28:29], v[28:29], v[152:153], v[154:155]
v_pk_fma_f32 v[30:31], v[30:31], v[152:153], v[154:155]
v_pk_mul_f32 v[24:25], v[72:73], v[24:25]
v_pk_mul_f32 v[26:27], v[74:75], v[26:27]
v_pk_mul_f32 v[28:29], v[76:77], v[28:29]
v_pk_mul_f32 v[30:31], v[78:79], v[30:31]
v_cvt_pk_bf16_f32 v44, v24, v25
v_cvt_pk_bf16_f32 v45, v26, v27
v_cvt_pk_bf16_f32 v46, v28, v29
v_cvt_pk_bf16_f32 v47, v30, v31
buffer_store_dwordx4 v[44:47], v1, s[12:15], s34 offen offset:1024 sc1
s_add_u32 s32, s24, 1
s_and_b32 s32, s32, 3
s_lshl_b32 s32, s32, 11
s_add_u32 s34, s33, s32

v_pk_mul_f32 v[16:17], v[80:81], v[150:151]
v_pk_mul_f32 v[18:19], v[82:83], v[150:151]
v_pk_mul_f32 v[20:21], v[84:85], v[150:151]
v_pk_mul_f32 v[22:23], v[86:87], v[150:151]
v_exp_f32 v16, v16
v_exp_f32 v17, v17
v_exp_f32 v18, v18
v_exp_f32 v19, v19
v_exp_f32 v20, v20
v_exp_f32 v21, v21
v_exp_f32 v22, v22
v_exp_f32 v23, v23
v_pk_add_f32 v[24:25], v[16:17], s[52:53]
v_pk_add_f32 v[26:27], v[18:19], s[52:53]
v_pk_add_f32 v[28:29], v[20:21], s[52:53]
v_pk_add_f32 v[30:31], v[22:23], s[52:53]
v_pk_fma_f32 v[24:25], v[16:17], v[24:25], s[52:53]
v_pk_fma_f32 v[26:27], v[18:19], v[26:27], s[52:53]
v_pk_fma_f32 v[28:29], v[20:21], v[28:29], s[52:53]
v_pk_fma_f32 v[30:31], v[22:23], v[30:31], s[52:53]
v_rcp_f32 v24, v24
v_rcp_f32 v25, v25
v_rcp_f32 v26, v26
v_rcp_f32 v27, v27
v_rcp_f32 v28, v28
v_rcp_f32 v29, v29
v_rcp_f32 v30, v30
v_rcp_f32 v31, v31
v_pk_fma_f32 v[24:25], v[24:25], v[152:153], v[154:155]
v_pk_fma_f32 v[26:27], v[26:27], v[152:153], v[154:155]
v_pk_fma_f32 v[28:29], v[28:29], v[152:153], v[154:155]
v_pk_fma_f32 v[30:31], v[30:31], v[152:153], v[154:155]
v_pk_mul_f32 v[24:25], v[80:81], v[24:25]
v_pk_mul_f32 v[26:27], v[82:83], v[26:27]
v_pk_mul_f32 v[28:29], v[84:85], v[28:29]
v_pk_mul_f32 v[30:31], v[86:87], v[30:31]
v_cvt_pk_bf16_f32 v40, v24, v25
v_cvt_pk_bf16_f32 v41, v26, v27
v_cvt_pk_bf16_f32 v42, v28, v29
v_cvt_pk_bf16_f32 v43, v30, v31
buffer_store_dwordx4 v[40:43], v1, s[12:15], s34 offen offset:0 sc1
v_pk_mul_f32 v[16:17], v[88:89], v[150:151]
v_pk_mul_f32 v[18:19], v[90:91], v[150:151]
v_pk_mul_f32 v[20:21], v[92:93], v[150:151]
v_pk_mul_f32 v[22:23], v[94:95], v[150:151]
v_exp_f32 v16, v16
v_exp_f32 v17, v17
v_exp_f32 v18, v18
v_exp_f32 v19, v19
v_exp_f32 v20, v20
v_exp_f32 v21, v21
v_exp_f32 v22, v22
v_exp_f32 v23, v23
v_pk_add_f32 v[24:25], v[16:17], s[52:53]
v_pk_add_f32 v[26:27], v[18:19], s[52:53]
v_pk_add_f32 v[28:29], v[20:21], s[52:53]
v_pk_add_f32 v[30:31], v[22:23], s[52:53]
v_pk_fma_f32 v[24:25], v[16:17], v[24:25], s[52:53]
v_pk_fma_f32 v[26:27], v[18:19], v[26:27], s[52:53]
v_pk_fma_f32 v[28:29], v[20:21], v[28:29], s[52:53]
v_pk_fma_f32 v[30:31], v[22:23], v[30:31], s[52:53]
v_rcp_f32 v24, v24
v_rcp_f32 v25, v25
v_rcp_f32 v26, v26
v_rcp_f32 v27, v27
v_rcp_f32 v28, v28
v_rcp_f32 v29, v29
v_rcp_f32 v30, v30
v_rcp_f32 v31, v31
v_pk_fma_f32 v[24:25], v[24:25], v[152:153], v[154:155]
v_pk_fma_f32 v[26:27], v[26:27], v[152:153], v[154:155]
v_pk_fma_f32 v[28:29], v[28:29], v[152:153], v[154:155]
v_pk_fma_f32 v[30:31], v[30:31], v[152:153], v[154:155]
v_pk_mul_f32 v[24:25], v[88:89], v[24:25]
v_pk_mul_f32 v[26:27], v[90:91], v[26:27]
v_pk_mul_f32 v[28:29], v[92:93], v[28:29]
v_pk_mul_f32 v[30:31], v[94:95], v[30:31]
v_cvt_pk_bf16_f32 v44, v24, v25
v_cvt_pk_bf16_f32 v45, v26, v27
v_cvt_pk_bf16_f32 v46, v28, v29
v_cvt_pk_bf16_f32 v47, v30, v31
buffer_store_dwordx4 v[44:47], v1, s[12:15], s34 offen offset:1024 sc1
s_add_u32 s32, s24, 2
s_and_b32 s32, s32, 3
s_lshl_b32 s32, s32, 11
s_add_u32 s34, s33, s32

v_pk_mul_f32 v[16:17], v[96:97], v[150:151]
v_pk_mul_f32 v[18:19], v[98:99], v[150:151]
v_pk_mul_f32 v[20:21], v[100:101], v[150:151]
v_pk_mul_f32 v[22:23], v[102:103], v[150:151]
v_exp_f32 v16, v16
v_exp_f32 v17, v17
v_exp_f32 v18, v18
v_exp_f32 v19, v19
v_exp_f32 v20, v20
v_exp_f32 v21, v21
v_exp_f32 v22, v22
v_exp_f32 v23, v23
v_pk_add_f32 v[24:25], v[16:17], s[52:53]
v_pk_add_f32 v[26:27], v[18:19], s[52:53]
v_pk_add_f32 v[28:29], v[20:21], s[52:53]
v_pk_add_f32 v[30:31], v[22:23], s[52:53]
v_pk_fma_f32 v[24:25], v[16:17], v[24:25], s[52:53]
v_pk_fma_f32 v[26:27], v[18:19], v[26:27], s[52:53]
v_pk_fma_f32 v[28:29], v[20:21], v[28:29], s[52:53]
v_pk_fma_f32 v[30:31], v[22:23], v[30:31], s[52:53]
v_rcp_f32 v24, v24
v_rcp_f32 v25, v25
v_rcp_f32 v26, v26
v_rcp_f32 v27, v27
v_rcp_f32 v28, v28
v_rcp_f32 v29, v29
v_rcp_f32 v30, v30
v_rcp_f32 v31, v31
v_pk_fma_f32 v[24:25], v[24:25], v[152:153], v[154:155]
v_pk_fma_f32 v[26:27], v[26:27], v[152:153], v[154:155]
v_pk_fma_f32 v[28:29], v[28:29], v[152:153], v[154:155]
v_pk_fma_f32 v[30:31], v[30:31], v[152:153], v[154:155]
v_pk_mul_f32 v[24:25], v[96:97], v[24:25]
v_pk_mul_f32 v[26:27], v[98:99], v[26:27]
v_pk_mul_f32 v[28:29], v[100:101], v[28:29]
v_pk_mul_f32 v[30:31], v[102:103], v[30:31]
v_cvt_pk_bf16_f32 v40, v24, v25
v_cvt_pk_bf16_f32 v41, v26, v27
v_cvt_pk_bf16_f32 v42, v28, v29
v_cvt_pk_bf16_f32 v43, v30, v31
buffer_store_dwordx4 v[40:43], v1, s[12:15], s34 offen offset:0 sc1
v_pk_mul_f32 v[16:17], v[104:105], v[150:151]
v_pk_mul_f32 v[18:19], v[106:107], v[150:151]
v_pk_mul_f32 v[20:21], v[108:109], v[150:151]
v_pk_mul_f32 v[22:23], v[110:111], v[150:151]
v_exp_f32 v16, v16
v_exp_f32 v17, v17
v_exp_f32 v18, v18
v_exp_f32 v19, v19
v_exp_f32 v20, v20
v_exp_f32 v21, v21
v_exp_f32 v22, v22
v_exp_f32 v23, v23
v_pk_add_f32 v[24:25], v[16:17], s[52:53]
v_pk_add_f32 v[26:27], v[18:19], s[52:53]
v_pk_add_f32 v[28:29], v[20:21], s[52:53]
v_pk_add_f32 v[30:31], v[22:23], s[52:53]
v_pk_fma_f32 v[24:25], v[16:17], v[24:25], s[52:53]
v_pk_fma_f32 v[26:27], v[18:19], v[26:27], s[52:53]
v_pk_fma_f32 v[28:29], v[20:21], v[28:29], s[52:53]
v_pk_fma_f32 v[30:31], v[22:23], v[30:31], s[52:53]
v_rcp_f32 v24, v24
v_rcp_f32 v25, v25
v_rcp_f32 v26, v26
v_rcp_f32 v27, v27
v_rcp_f32 v28, v28
v_rcp_f32 v29, v29
v_rcp_f32 v30, v30
v_rcp_f32 v31, v31
v_pk_fma_f32 v[24:25], v[24:25], v[152:153], v[154:155]
v_pk_fma_f32 v[26:27], v[26:27], v[152:153], v[154:155]
v_pk_fma_f32 v[28:29], v[28:29], v[152:153], v[154:155]
v_pk_fma_f32 v[30:31], v[30:31], v[152:153], v[154:155]
v_pk_mul_f32 v[24:25], v[104:105], v[24:25]
v_pk_mul_f32 v[26:27], v[106:107], v[26:27]
v_pk_mul_f32 v[28:29], v[108:109], v[28:29]
v_pk_mul_f32 v[30:31], v[110:111], v[30:31]
v_cvt_pk_bf16_f32 v44, v24, v25
v_cvt_pk_bf16_f32 v45, v26, v27
v_cvt_pk_bf16_f32 v46, v28, v29
v_cvt_pk_bf16_f32 v47, v30, v31
buffer_store_dwordx4 v[44:47], v1, s[12:15], s34 offen offset:1024 sc1
s_add_u32 s32, s24, 3
s_and_b32 s32, s32, 3
s_lshl_b32 s32, s32, 11
s_add_u32 s34, s33, s32

v_pk_mul_f32 v[16:17], v[112:113], v[150:151]
v_pk_mul_f32 v[18:19], v[114:115], v[150:151]
v_pk_mul_f32 v[20:21], v[116:117], v[150:151]
v_pk_mul_f32 v[22:23], v[118:119], v[150:151]
v_exp_f32 v16, v16
v_exp_f32 v17, v17
v_exp_f32 v18, v18
v_exp_f32 v19, v19
v_exp_f32 v20, v20
v_exp_f32 v21, v21
v_exp_f32 v22, v22
v_exp_f32 v23, v23
v_pk_add_f32 v[24:25], v[16:17], s[52:53]
v_pk_add_f32 v[26:27], v[18:19], s[52:53]
v_pk_add_f32 v[28:29], v[20:21], s[52:53]
v_pk_add_f32 v[30:31], v[22:23], s[52:53]
v_pk_fma_f32 v[24:25], v[16:17], v[24:25], s[52:53]
v_pk_fma_f32 v[26:27], v[18:19], v[26:27], s[52:53]
v_pk_fma_f32 v[28:29], v[20:21], v[28:29], s[52:53]
v_pk_fma_f32 v[30:31], v[22:23], v[30:31], s[52:53]
v_rcp_f32 v24, v24
v_rcp_f32 v25, v25
v_rcp_f32 v26, v26
v_rcp_f32 v27, v27
v_rcp_f32 v28, v28
v_rcp_f32 v29, v29
v_rcp_f32 v30, v30
v_rcp_f32 v31, v31
v_pk_fma_f32 v[24:25], v[24:25], v[152:153], v[154:155]
v_pk_fma_f32 v[26:27], v[26:27], v[152:153], v[154:155]
v_pk_fma_f32 v[28:29], v[28:29], v[152:153], v[154:155]
v_pk_fma_f32 v[30:31], v[30:31], v[152:153], v[154:155]
v_pk_mul_f32 v[24:25], v[112:113], v[24:25]
v_pk_mul_f32 v[26:27], v[114:115], v[26:27]
v_pk_mul_f32 v[28:29], v[116:117], v[28:29]
v_pk_mul_f32 v[30:31], v[118:119], v[30:31]
v_cvt_pk_bf16_f32 v40, v24, v25
v_cvt_pk_bf16_f32 v41, v26, v27
v_cvt_pk_bf16_f32 v42, v28, v29
v_cvt_pk_bf16_f32 v43, v30, v31
buffer_store_dwordx4 v[40:43], v1, s[12:15], s34 offen offset:0 sc1
v_pk_mul_f32 v[16:17], v[120:121], v[150:151]
v_pk_mul_f32 v[18:19], v[122:123], v[150:151]
v_pk_mul_f32 v[20:21], v[124:125], v[150:151]
v_pk_mul_f32 v[22:23], v[126:127], v[150:151]
v_exp_f32 v16, v16
v_exp_f32 v17, v17
v_exp_f32 v18, v18
v_exp_f32 v19, v19
v_exp_f32 v20, v20
v_exp_f32 v21, v21
v_exp_f32 v22, v22
v_exp_f32 v23, v23
v_pk_add_f32 v[24:25], v[16:17], s[52:53]
v_pk_add_f32 v[26:27], v[18:19], s[52:53]
v_pk_add_f32 v[28:29], v[20:21], s[52:53]
v_pk_add_f32 v[30:31], v[22:23], s[52:53]
v_pk_fma_f32 v[24:25], v[16:17], v[24:25], s[52:53]
v_pk_fma_f32 v[26:27], v[18:19], v[26:27], s[52:53]
v_pk_fma_f32 v[28:29], v[20:21], v[28:29], s[52:53]
v_pk_fma_f32 v[30:31], v[22:23], v[30:31], s[52:53]
v_rcp_f32 v24, v24
v_rcp_f32 v25, v25
v_rcp_f32 v26, v26
v_rcp_f32 v27, v27
v_rcp_f32 v28, v28
v_rcp_f32 v29, v29
v_rcp_f32 v30, v30
v_rcp_f32 v31, v31
v_pk_fma_f32 v[24:25], v[24:25], v[152:153], v[154:155]
v_pk_fma_f32 v[26:27], v[26:27], v[152:153], v[154:155]
v_pk_fma_f32 v[28:29], v[28:29], v[152:153], v[154:155]
v_pk_fma_f32 v[30:31], v[30:31], v[152:153], v[154:155]
v_pk_mul_f32 v[24:25], v[120:121], v[24:25]
v_pk_mul_f32 v[26:27], v[122:123], v[26:27]
v_pk_mul_f32 v[28:29], v[124:125], v[28:29]
v_pk_mul_f32 v[30:31], v[126:127], v[30:31]
v_cvt_pk_bf16_f32 v44, v24, v25
v_cvt_pk_bf16_f32 v45, v26, v27
v_cvt_pk_bf16_f32 v46, v28, v29
v_cvt_pk_bf16_f32 v47, v30, v31
buffer_store_dwordx4 v[44:47], v1, s[12:15], s34 offen offset:1024 sc1
s_lshl_b32 s68, s25, 10
s_lshl_b32 s34, s26, 6
s_add_u32 s68, s68, s34
s_waitcnt vmcnt(0)
s_barrier
v_cmp_eq_u32 vcc, 0, v0
s_and_saveexec_b64 s[60:61], vcc
s_cbranch_execz L_sg_7
v_mov_b32 v16, s69
v_mov_b32 v17, 0
buffer_store_dword v16, v17, s[44:47], s68 offen sc1
L_sg_7:
s_mov_b64 exec, s[60:61]

s_load_dwordx2 s[36:37], s[0:1], 0
s_load_dwordx2 s[38:39], s[0:1], 80
s_load_dwordx2 s[40:41], s[0:1], 88
s_load_dwordx2 s[42:43], s[0:1], 104
v_lshrrev_b32 v1, 6, v0
v_and_b32 v2, 63, v0
s_and_b32 s31, s2, 7
s_lshr_b32 s32, s2, 3
v_readfirstlane_b32 s24, v1
s_lshl_b32 s26, s31, 2
s_and_b32 s31, s32, 3
s_add_u32 s26, s26, s31
s_lshr_b32 s27, s32, 2
s_waitcnt lgkmcnt(0)

s_mov_b32 s4, s36
s_mov_b32 s5, s37
s_mov_b32 s6, 1835008
s_mov_b32 s7, 0x20000
s_mov_b32 s8, s38
s_mov_b32 s9, s39
s_mov_b32 s10, 1605632
s_mov_b32 s11, 0x20000
s_mov_b32 s12, s42
s_mov_b32 s13, s43
s_mov_b32 s14, 7340032
s_mov_b32 s15, 0x20000
s_add_u32 s16, s42, 10485760
s_addc_u32 s17, s43, 0
s_mov_b32 s18, 1835008
s_mov_b32 s19, 0x20000
s_mov_b32 s20, s40
s_mov_b32 s21, s41
s_mov_b32 s22, 1835008
s_mov_b32 s23, 0x20000
v_lshrrev_b32 v8, 3, v2
v_mul_u32_u24 v4, 896, v8
v_lshrrev_b32 v9, 2, v2
v_and_b32 v9, 1, v9
v_lshrrev_b32 v10, 4, v2
v_and_b32 v10, 1, v10
v_xor_b32 v9, v9, v10
v_lshl_add_u32 v4, v9, 6, v4
v_and_b32 v9, 3, v2
v_lshl_add_u32 v4, v9, 4, v4
v_lshlrev_b32 v5, 4, v2
s_lshl_b32 s31, s26, 1
s_mul_i32 s31, s31, 112
s_mul_i32 s32, s24, 28
s_add_u32 s31, s31, s32
s_lshl_b32 s28, s31, 10
s_add_u32 s29, s28, 114688
s_mul_i32 s30, s32, 14336
s_lshl_b32 s31, s27, 7
s_add_u32 s30, s30, s31
s_lshl_b32 s33, s24, 14

v_and_b32 v8, 15, v2
v_lshrrev_b32 v9, 2, v8
v_and_b32 v10, 3, v8
v_lshrrev_b32 v11, 5, v2
v_lshl_add_u32 v11, v11, 2, v9
v_lshlrev_b32 v11, 7, v11
v_lshl_add_u32 v11, v10, 3, v11
v_lshrrev_b32 v12, 4, v2
v_and_b32 v12, 1, v12
v_lshl_add_u32 v11, v12, 5, v11
v_lshrrev_b32 v9, 1, v9
v_lshl_add_u32 v6, v9, 6, v11
v_xor_b32 v9, 1, v9
v_lshl_add_u32 v7, v9, 6, v11
v_add_u32 v6, s33, v6
v_add_u32 v7, s33, v7

v_and_b32 v9, 31, v2
v_lshrrev_b32 v10, 5, v2
v_lshlrev_b32 v11, 14, v10
v_and_b32 v12, 30, v2
v_lshl_add_u32 v11, v12, 1, v11
v_mul_u32_u24 v14, 896, v9
v_lshl_add_u32 v14, v10, 3, v14
v_min_u32 v193, 15, v2
v_lshlrev_b32 v193, 6, v193
s_lshr_b32 s31, s24, 1
s_and_b32 s32, s24, 1
s_lshl_b32 s48, s27, 1
s_add_u32 s48, s48, s31
s_lshl_b32 s49, s26, 1
s_add_u32 s49, s49, s32
s_mul_i32 s50, s49, 28672
s_lshl_b32 s51, s48, 6
s_add_u32 s50, s50, s51
s_lshl_b32 s51, s49, 6
s_lshl_b32 s49, s48, 10
s_add_u32 s49, s49, 32768
s_lshl_b32 s48, s48, 17
s_add_u32 s48, s48, s51

s_add_u32 m0, s33, 0
s_add_u32 s31, s30, 0
buffer_load_dwordx4 v4, s[8:11], s31 offen lds
s_add_u32 m0, s33, 1024
s_add_u32 s31, s31, 7168
buffer_load_dwordx4 v4, s[8:11], s31 offen lds

s_add_u32 m0, s33, 2048
s_add_u32 s31, s30, 14336
buffer_load_dwordx4 v4, s[8:11], s31 offen lds
s_add_u32 m0, s33, 3072
s_add_u32 s31, s31, 7168
buffer_load_dwordx4 v4, s[8:11], s31 offen lds

s_add_u32 m0, s33, 4096
s_add_u32 s31, s30, 28672
buffer_load_dwordx4 v4, s[8:11], s31 offen lds
s_add_u32 m0, s33, 5120
s_add_u32 s31, s31, 7168
buffer_load_dwordx4 v4, s[8:11], s31 offen lds

s_add_u32 m0, s33, 6144
s_add_u32 s31, s30, 43008
buffer_load_dwordx4 v4, s[8:11], s31 offen lds
s_add_u32 m0, s33, 7168
s_add_u32 s31, s31, 7168
buffer_load_dwordx4 v4, s[8:11], s31 offen lds

s_add_u32 m0, s33, 8192
s_add_u32 s31, s30, 57344
buffer_load_dwordx4 v4, s[8:11], s31 offen lds
s_add_u32 m0, s33, 9216
s_add_u32 s31, s31, 7168
buffer_load_dwordx4 v4, s[8:11], s31 offen lds

s_add_u32 m0, s33, 10240
s_add_u32 s31, s30, 71680
buffer_load_dwordx4 v4, s[8:11], s31 offen lds
s_add_u32 m0, s33, 11264
s_add_u32 s31, s31, 7168
buffer_load_dwordx4 v4, s[8:11], s31 offen lds

s_add_u32 m0, s33, 12288
s_add_u32 s31, s30, 86016
buffer_load_dwordx4 v4, s[8:11], s31 offen lds
s_add_u32 m0, s33, 13312
s_add_u32 s31, s31, 7168
buffer_load_dwordx4 v4, s[8:11], s31 offen lds

v_mov_b32 v64, 0
v_mov_b32 v65, 0
v_mov_b32 v66, 0
v_mov_b32 v67, 0
v_mov_b32 v68, 0
v_mov_b32 v69, 0
v_mov_b32 v70, 0
v_mov_b32 v71, 0
v_mov_b32 v72, 0
v_mov_b32 v73, 0
v_mov_b32 v74, 0
v_mov_b32 v75, 0
v_mov_b32 v76, 0
v_mov_b32 v77, 0
v_mov_b32 v78, 0
v_mov_b32 v79, 0
v_mov_b32 v80, 0
v_mov_b32 v81, 0
v_mov_b32 v82, 0
v_mov_b32 v83, 0
v_mov_b32 v84, 0
v_mov_b32 v85, 0
v_mov_b32 v86, 0
v_mov_b32 v87, 0
v_mov_b32 v88, 0
v_mov_b32 v89, 0
v_mov_b32 v90, 0
v_mov_b32 v91, 0
v_mov_b32 v92, 0
v_mov_b32 v93, 0
v_mov_b32 v94, 0
v_mov_b32 v95, 0
v_mov_b32 v96, 0
v_mov_b32 v97, 0
v_mov_b32 v98, 0
v_mov_b32 v99, 0
v_mov_b32 v100, 0
v_mov_b32 v101, 0
v_mov_b32 v102, 0
v_mov_b32 v103, 0
v_mov_b32 v104, 0
v_mov_b32 v105, 0
v_mov_b32 v106, 0
v_mov_b32 v107, 0
v_mov_b32 v108, 0
v_mov_b32 v109, 0
v_mov_b32 v110, 0
v_mov_b32 v111, 0
v_mov_b32 v112, 0
v_mov_b32 v113, 0
v_mov_b32 v114, 0
v_mov_b32 v115, 0
v_mov_b32 v116, 0
v_mov_b32 v117, 0
v_mov_b32 v118, 0
v_mov_b32 v119, 0
v_mov_b32 v120, 0
v_mov_b32 v121, 0
v_mov_b32 v122, 0
v_mov_b32 v123, 0
v_mov_b32 v124, 0
v_mov_b32 v125, 0
v_mov_b32 v126, 0
v_mov_b32 v127, 0
s_lshr_b32 s34, s26, 1
s_lshl_b32 s34, s34, 10
s_mul_i32 s35, s24, 28
s_lshr_b32 s35, s35, 3
s_lshl_b32 s35, s35, 6
s_add_u32 s56, s34, s35
v_min_u32 v216, 3, v2
v_lshlrev_b32 v216, 6, v216
s_mov_b32 s61, 20000
L_pw_8:
buffer_load_dword v217, v216, s[44:47], s56 offen sc1
s_sub_u32 s61, s61, 1
s_cbranch_scc1 L_pw_8_d
s_waitcnt vmcnt(0)
v_cmp_ne_u32 vcc, s69, v217
s_and_b32 s55, vcc_lo, 3
s_cbranch_scc1 L_pw_8
L_pw_8_d:

s_add_u32 s31, s28, 0
s_add_u32 s32, s29, 0
buffer_load_dwordx4 v[128:131], v5, s[12:15], s31 offen sc1
buffer_load_dwordx4 v[132:135], v5, s[12:15], s32 offen sc1

s_add_u32 s31, s28, 1024
s_add_u32 s32, s29, 1024
buffer_load_dwordx4 v[136:139], v5, s[12:15], s31 offen sc1
buffer_load_dwordx4 v[140:143], v5, s[12:15], s32 offen sc1

s_add_u32 s31, s28, 2048
s_add_u32 s32, s29, 2048
buffer_load_dwordx4 v[144:147], v5, s[12:15], s31 offen sc1
buffer_load_dwordx4 v[148:151], v5, s[12:15], s32 offen sc1

s_add_u32 s31, s28, 3072
s_add_u32 s32, s29, 3072
buffer_load_dwordx4 v[152:155], v5, s[12:15], s31 offen sc1
buffer_load_dwordx4 v[156:159], v5, s[12:15], s32 offen sc1

s_add_u32 s31, s28, 4096
s_add_u32 s32, s29, 4096
buffer_load_dwordx4 v[160:163], v5, s[12:15], s31 offen sc1
buffer_load_dwordx4 v[164:167], v5, s[12:15], s32 offen sc1

s_add_u32 s31, s28, 5120
s_add_u32 s32, s29, 5120
buffer_load_dwordx4 v[168:171], v5, s[12:15], s31 offen sc1
buffer_load_dwordx4 v[172:175], v5, s[12:15], s32 offen sc1

s_add_u32 s31, s28, 6144
s_add_u32 s32, s29, 6144
buffer_load_dwordx4 v[176:179], v5, s[12:15], s31 offen sc1
buffer_load_dwordx4 v[180:183], v5, s[12:15], s32 offen sc1

s_waitcnt vmcnt(12)
ds_read_b64_tr_b16 v[16:17], v6 offset:0
ds_read_b64_tr_b16 v[18:19], v6 offset:1024
ds_read_b64_tr_b16 v[20:21], v7 offset:0
ds_read_b64_tr_b16 v[22:23], v7 offset:1024
s_add_u32 s52, s30, 100352
s_add_u32 s53, s28, 7168
s_add_u32 s54, s29, 7168
v_add_u32 v15, 7168, v4
s_waitcnt vmcnt(10) lgkmcnt(2)
v_mfma_f32_32x32x16_bf16 v[64:79], v[16:19], v[128:131], v[64:79]
s_add_u32 m0, s33, 14336
ds_read_b64_tr_b16 v[24:25], v6 offset:2048
ds_read_b64_tr_b16 v[26:27], v6 offset:3072
buffer_load_dwordx4 v4, s[8:11], s52 offen lds
v_mfma_f32_32x32x16_bf16 v[80:95], v[16:19], v[132:135], v[80:95]
s_add_u32 m0, s33, 15360
ds_read_b64_tr_b16 v[28:29], v7 offset:2048
ds_read_b64_tr_b16 v[30:31], v7 offset:3072
buffer_load_dwordx4 v15, s[8:11], s52 offen lds
s_add_u32 s52, s52, 14336
s_waitcnt lgkmcnt(4)
v_mfma_f32_32x32x16_bf16 v[96:111], v[20:23], v[128:131], v[96:111]
buffer_load_dwordx4 v[184:187], v5, s[12:15], s53 offen sc1
s_add_u32 s53, s53, 1024
v_mfma_f32_32x32x16_bf16 v[112:127], v[20:23], v[132:135], v[112:127]
buffer_load_dwordx4 v[188:191], v5, s[12:15], s54 offen sc1
s_add_u32 s54, s54, 1024
buffer_load_dword v218, v216, s[44:47], s56 offen sc1
s_waitcnt vmcnt(13) lgkmcnt(2)
v_mfma_f32_32x32x16_bf16 v[64:79], v[24:27], v[136:139], v[64:79]
s_add_u32 m0, s33, 0
ds_read_b64_tr_b16 v[16:17], v6 offset:4096
ds_read_b64_tr_b16 v[18:19], v6 offset:5120
buffer_load_dwordx4 v4, s[8:11], s52 offen lds
v_mfma_f32_32x32x16_bf16 v[80:95], v[24:27], v[140:143], v[80:95]
s_add_u32 m0, s33, 1024
ds_read_b64_tr_b16 v[20:21], v7 offset:4096
ds_read_b64_tr_b16 v[22:23], v7 offset:5120
buffer_load_dwordx4 v15, s[8:11], s52 offen lds
s_add_u32 s52, s52, 14336
s_waitcnt lgkmcnt(4)
v_mfma_f32_32x32x16_bf16 v[96:111], v[28:31], v[136:139], v[96:111]
buffer_load_dwordx4 v[128:131], v5, s[12:15], s53 offen sc1
s_add_u32 s53, s53, 1024
v_mfma_f32_32x32x16_bf16 v[112:127], v[28:31], v[140:143], v[112:127]
buffer_load_dwordx4 v[132:135], v5, s[12:15], s54 offen sc1
s_add_u32 s54, s54, 1024
s_waitcnt vmcnt(15) lgkmcnt(2)
v_mfma_f32_32x32x16_bf16 v[64:79], v[16:19], v[144:147], v[64:79]
s_add_u32 m0, s33, 2048
ds_read_b64_tr_b16 v[24:25], v6 offset:6144
ds_read_b64_tr_b16 v[26:27], v6 offset:7168
buffer_load_dwordx4 v4, s[8:11], s52 offen lds
v_mfma_f32_32x32x16_bf16 v[80:95], v[16:19], v[148:151], v[80:95]
s_add_u32 m0, s33, 3072
ds_read_b64_tr_b16 v[28:29], v7 offset:6144
ds_read_b64_tr_b16 v[30:31], v7 offset:7168
buffer_load_dwordx4 v15, s[8:11], s52 offen lds
s_add_u32 s52, s52, 14336
s_waitcnt lgkmcnt(4)
v_mfma_f32_32x32x16_bf16 v[96:111], v[20:23], v[144:147], v[96:111]
buffer_load_dwordx4 v[136:139], v5, s[12:15], s53 offen sc1
s_add_u32 s53, s53, 1024
v_mfma_f32_32x32x16_bf16 v[112:127], v[20:23], v[148:151], v[112:127]
buffer_load_dwordx4 v[140:143], v5, s[12:15], s54 offen sc1
s_add_u32 s54, s54, 1024
s_waitcnt vmcnt(17) lgkmcnt(2)
v_mfma_f32_32x32x16_bf16 v[64:79], v[24:27], v[152:155], v[64:79]
s_add_u32 m0, s33, 4096
ds_read_b64_tr_b16 v[16:17], v6 offset:8192
ds_read_b64_tr_b16 v[18:19], v6 offset:9216
buffer_load_dwordx4 v4, s[8:11], s52 offen lds
v_mfma_f32_32x32x16_bf16 v[80:95], v[24:27], v[156:159], v[80:95]
s_add_u32 m0, s33, 5120
ds_read_b64_tr_b16 v[20:21], v7 offset:8192
ds_read_b64_tr_b16 v[22:23], v7 offset:9216
buffer_load_dwordx4 v15, s[8:11], s52 offen lds
s_add_u32 s52, s52, 14336
s_waitcnt lgkmcnt(4)
v_mfma_f32_32x32x16_bf16 v[96:111], v[28:31], v[152:155], v[96:111]
buffer_load_dwordx4 v[144:147], v5, s[12:15], s53 offen sc1
s_add_u32 s53, s53, 1024
v_mfma_f32_32x32x16_bf16 v[112:127], v[28:31], v[156:159], v[112:127]
buffer_load_dwordx4 v[148:151], v5, s[12:15], s54 offen sc1
s_add_u32 s54, s54, 1024
s_waitcnt vmcnt(19) lgkmcnt(2)
v_mfma_f32_32x32x16_bf16 v[64:79], v[16:19], v[160:163], v[64:79]
s_add_u32 m0, s33, 6144
ds_read_b64_tr_b16 v[24:25], v6 offset:10240
ds_read_b64_tr_b16 v[26:27], v6 offset:11264
buffer_load_dwordx4 v4, s[8:11], s52 offen lds
v_mfma_f32_32x32x16_bf16 v[80:95], v[16:19], v[164:167], v[80:95]
s_add_u32 m0, s33, 7168
ds_read_b64_tr_b16 v[28:29], v7 offset:10240
ds_read_b64_tr_b16 v[30:31], v7 offset:11264
buffer_load_dwordx4 v15, s[8:11], s52 offen lds
s_add_u32 s52, s52, 14336
s_waitcnt lgkmcnt(4)
v_mfma_f32_32x32x16_bf16 v[96:111], v[20:23], v[160:163], v[96:111]
buffer_load_dwordx4 v[152:155], v5, s[12:15], s53 offen sc1
s_add_u32 s53, s53, 1024
v_mfma_f32_32x32x16_bf16 v[112:127], v[20:23], v[164:167], v[112:127]
buffer_load_dwordx4 v[156:159], v5, s[12:15], s54 offen sc1
s_add_u32 s54, s54, 1024
s_waitcnt vmcnt(16) lgkmcnt(2)
v_cmp_ne_u32 vcc, s69, v218
s_and_b32 s55, vcc_lo, 4
s_cbranch_scc0 L_pg_9_d
s_mov_b32 s61, 20000
L_pg_9:
buffer_load_dword v218, v216, s[44:47], s56 offen sc1
s_sub_u32 s61, s61, 1
s_cbranch_scc1 L_pg_9_d
s_waitcnt vmcnt(0)
v_cmp_ne_u32 vcc, s69, v218
s_and_b32 s55, vcc_lo, 4
s_cbranch_scc1 L_pg_9
L_pg_9_d:

v_mfma_f32_32x32x16_bf16 v[64:79], v[24:27], v[168:171], v[64:79]
s_add_u32 m0, s33, 8192
ds_read_b64_tr_b16 v[16:17], v6 offset:12288
ds_read_b64_tr_b16 v[18:19], v6 offset:13312
buffer_load_dwordx4 v4, s[8:11], s52 offen lds
v_mfma_f32_32x32x16_bf16 v[80:95], v[24:27], v[172:175], v[80:95]
s_add_u32 m0, s33, 9216
ds_read_b64_tr_b16 v[20:21], v7 offset:12288
ds_read_b64_tr_b16 v[22:23], v7 offset:13312
buffer_load_dwordx4 v15, s[8:11], s52 offen lds
s_add_u32 s52, s52, 14336
s_waitcnt lgkmcnt(4)
v_mfma_f32_32x32x16_bf16 v[96:111], v[28:31], v[168:171], v[96:111]
buffer_load_dwordx4 v[160:163], v5, s[12:15], s53 offen sc1
s_add_u32 s53, s53, 1024
v_mfma_f32_32x32x16_bf16 v[112:127], v[28:31], v[172:175], v[112:127]
buffer_load_dwordx4 v[164:167], v5, s[12:15], s54 offen sc1
s_add_u32 s54, s54, 1024
s_waitcnt vmcnt(21) lgkmcnt(2)
v_mfma_f32_32x32x16_bf16 v[64:79], v[16:19], v[176:179], v[64:79]
s_add_u32 m0, s33, 10240
ds_read_b64_tr_b16 v[24:25], v6 offset:14336
ds_read_b64_tr_b16 v[26:27], v6 offset:15360
buffer_load_dwordx4 v4, s[8:11], s52 offen lds
v_mfma_f32_32x32x16_bf16 v[80:95], v[16:19], v[180:183], v[80:95]
s_add_u32 m0, s33, 11264
ds_read_b64_tr_b16 v[28:29], v7 offset:14336
ds_read_b64_tr_b16 v[30:31], v7 offset:15360
buffer_load_dwordx4 v15, s[8:11], s52 offen lds
s_add_u32 s52, s52, 14336
s_waitcnt lgkmcnt(4)
v_mfma_f32_32x32x16_bf16 v[96:111], v[20:23], v[176:179], v[96:111]
buffer_load_dwordx4 v[168:171], v5, s[12:15], s53 offen sc1
s_add_u32 s53, s53, 1024
v_mfma_f32_32x32x16_bf16 v[112:127], v[20:23], v[180:183], v[112:127]
buffer_load_dwordx4 v[172:175], v5, s[12:15], s54 offen sc1
s_add_u32 s54, s54, 1024
s_waitcnt vmcnt(20) lgkmcnt(2)
v_mfma_f32_32x32x16_bf16 v[64:79], v[24:27], v[184:187], v[64:79]
s_add_u32 m0, s33, 12288
ds_read_b64_tr_b16 v[16:17], v6 offset:0
ds_read_b64_tr_b16 v[18:19], v6 offset:1024
buffer_load_dwordx4 v4, s[8:11], s52 offen lds
v_mfma_f32_32x32x16_bf16 v[80:95], v[24:27], v[188:191], v[80:95]
s_add_u32 m0, s33, 13312
ds_read_b64_tr_b16 v[20:21], v7 offset:0
ds_read_b64_tr_b16 v[22:23], v7 offset:1024
buffer_load_dwordx4 v15, s[8:11], s52 offen lds
s_add_u32 s52, s52, 14336
s_waitcnt lgkmcnt(4)
v_mfma_f32_32x32x16_bf16 v[96:111], v[28:31], v[184:187], v[96:111]
buffer_load_dwordx4 v[176:179], v5, s[12:15], s53 offen sc1
s_add_u32 s53, s53, 1024
v_mfma_f32_32x32x16_bf16 v[112:127], v[28:31], v[188:191], v[112:127]
buffer_load_dwordx4 v[180:183], v5, s[12:15], s54 offen sc1
s_add_u32 s54, s54, 1024
s_waitcnt vmcnt(20) lgkmcnt(2)
v_mfma_f32_32x32x16_bf16 v[64:79], v[16:19], v[128:131], v[64:79]
s_add_u32 m0, s33, 14336
ds_read_b64_tr_b16 v[24:25], v6 offset:2048
ds_read_b64_tr_b16 v[26:27], v6 offset:3072
buffer_load_dwordx4 v4, s[8:11], s52 offen lds
v_mfma_f32_32x32x16_bf16 v[80:95], v[16:19], v[132:135], v[80:95]
s_add_u32 m0, s33, 15360
ds_read_b64_tr_b16 v[28:29], v7 offset:2048
ds_read_b64_tr_b16 v[30:31], v7 offset:3072
buffer_load_dwordx4 v15, s[8:11], s52 offen lds
s_add_u32 s52, s52, 14336
s_waitcnt lgkmcnt(4)
v_mfma_f32_32x32x16_bf16 v[96:111], v[20:23], v[128:131], v[96:111]
buffer_load_dwordx4 v[184:187], v5, s[12:15], s53 offen sc1
s_add_u32 s53, s53, 1024
v_mfma_f32_32x32x16_bf16 v[112:127], v[20:23], v[132:135], v[112:127]
buffer_load_dwordx4 v[188:191], v5, s[12:15], s54 offen sc1
s_add_u32 s54, s54, 1024
buffer_load_dword v219, v216, s[44:47], s56 offen sc1
s_waitcnt vmcnt(21) lgkmcnt(2)
v_mfma_f32_32x32x16_bf16 v[64:79], v[24:27], v[136:139], v[64:79]
s_add_u32 m0, s33, 0
ds_read_b64_tr_b16 v[16:17], v6 offset:4096
ds_read_b64_tr_b16 v[18:19], v6 offset:5120
buffer_load_dwordx4 v4, s[8:11], s52 offen lds
v_mfma_f32_32x32x16_bf16 v[80:95], v[24:27], v[140:143], v[80:95]
s_add_u32 m0, s33, 1024
ds_read_b64_tr_b16 v[20:21], v7 offset:4096
ds_read_b64_tr_b16 v[22:23], v7 offset:5120
buffer_load_dwordx4 v15, s[8:11], s52 offen lds
s_add_u32 s52, s52, 14336
s_waitcnt lgkmcnt(4)
v_mfma_f32_32x32x16_bf16 v[96:111], v[28:31], v[136:139], v[96:111]
buffer_load_dwordx4 v[128:131], v5, s[12:15], s53 offen sc1
s_add_u32 s53, s53, 1024
v_mfma_f32_32x32x16_bf16 v[112:127], v[28:31], v[140:143], v[112:127]
buffer_load_dwordx4 v[132:135], v5, s[12:15], s54 offen sc1
s_add_u32 s54, s54, 1024
s_waitcnt vmcnt(21) lgkmcnt(2)
v_mfma_f32_32x32x16_bf16 v[64:79], v[16:19], v[144:147], v[64:79]
s_add_u32 m0, s33, 2048
ds_read_b64_tr_b16 v[24:25], v6 offset:6144
ds_read_b64_tr_b16 v[26:27], v6 offset:7168
buffer_load_dwordx4 v4, s[8:11], s52 offen lds
v_mfma_f32_32x32x16_bf16 v[80:95], v[16:19], v[148:151], v[80:95]
s_add_u32 m0, s33, 3072
ds_read_b64_tr_b16 v[28:29], v7 offset:6144
ds_read_b64_tr_b16 v[30:31], v7 offset:7168
buffer_load_dwordx4 v15, s[8:11], s52 offen lds
s_add_u32 s52, s52, 14336
s_waitcnt lgkmcnt(4)
v_mfma_f32_32x32x16_bf16 v[96:111], v[20:23], v[144:147], v[96:111]
buffer_load_dwordx4 v[136:139], v5, s[12:15], s53 offen sc1
s_add_u32 s53, s53, 1024
v_mfma_f32_32x32x16_bf16 v[112:127], v[20:23], v[148:151], v[112:127]
buffer_load_dwordx4 v[140:143], v5, s[12:15], s54 offen sc1
s_add_u32 s54, s54, 1024
s_waitcnt vmcnt(21) lgkmcnt(2)
v_mfma_f32_32x32x16_bf16 v[64:79], v[24:27], v[152:155], v[64:79]
s_add_u32 m0, s33, 4096
ds_read_b64_tr_b16 v[16:17], v6 offset:8192
ds_read_b64_tr_b16 v[18:19], v6 offset:9216
buffer_load_dwordx4 v4, s[8:11], s52 offen lds
v_mfma_f32_32x32x16_bf16 v[80:95], v[24:27], v[156:159], v[80:95]
s_add_u32 m0, s33, 5120
ds_read_b64_tr_b16 v[20:21], v7 offset:8192
ds_read_b64_tr_b16 v[22:23], v7 offset:9216
buffer_load_dwordx4 v15, s[8:11], s52 offen lds
s_add_u32 s52, s52, 14336
s_waitcnt lgkmcnt(4)
v_mfma_f32_32x32x16_bf16 v[96:111], v[28:31], v[152:155], v[96:111]
buffer_load_dwordx4 v[144:147], v5, s[12:15], s53 offen sc1
s_add_u32 s53, s53, 1024
v_mfma_f32_32x32x16_bf16 v[112:127], v[28:31], v[156:159], v[112:127]
buffer_load_dwordx4 v[148:151], v5, s[12:15], s54 offen sc1
s_add_u32 s54, s54, 1024
s_waitcnt vmcnt(21) lgkmcnt(2)
v_mfma_f32_32x32x16_bf16 v[64:79], v[16:19], v[160:163], v[64:79]
s_add_u32 m0, s33, 6144
ds_read_b64_tr_b16 v[24:25], v6 offset:10240
ds_read_b64_tr_b16 v[26:27], v6 offset:11264
buffer_load_dwordx4 v4, s[8:11], s52 offen lds
v_mfma_f32_32x32x16_bf16 v[80:95], v[16:19], v[164:167], v[80:95]
s_add_u32 m0, s33, 7168
ds_read_b64_tr_b16 v[28:29], v7 offset:10240
ds_read_b64_tr_b16 v[30:31], v7 offset:11264
buffer_load_dwordx4 v15, s[8:11], s52 offen lds
s_add_u32 s52, s52, 14336
s_waitcnt lgkmcnt(4)
v_mfma_f32_32x32x16_bf16 v[96:111], v[20:23], v[160:163], v[96:111]
buffer_load_dwordx4 v[152:155], v5, s[12:15], s53 offen sc1
s_add_u32 s53, s53, 1024
v_mfma_f32_32x32x16_bf16 v[112:127], v[20:23], v[164:167], v[112:127]
buffer_load_dwordx4 v[156:159], v5, s[12:15], s54 offen sc1
s_add_u32 s54, s54, 1024
s_waitcnt vmcnt(16) lgkmcnt(2)
v_cmp_ne_u32 vcc, s69, v219
s_and_b32 s55, vcc_lo, 8
s_cbranch_scc0 L_pg_10_d
s_mov_b32 s61, 20000
L_pg_10:
buffer_load_dword v219, v216, s[44:47], s56 offen sc1
s_sub_u32 s61, s61, 1
s_cbranch_scc1 L_pg_10_d
s_waitcnt vmcnt(0)
v_cmp_ne_u32 vcc, s69, v219
s_and_b32 s55, vcc_lo, 8
s_cbranch_scc1 L_pg_10
L_pg_10_d:

v_mfma_f32_32x32x16_bf16 v[64:79], v[24:27], v[168:171], v[64:79]
s_add_u32 m0, s33, 8192
ds_read_b64_tr_b16 v[16:17], v6 offset:12288
ds_read_b64_tr_b16 v[18:19], v6 offset:13312
buffer_load_dwordx4 v4, s[8:11], s52 offen lds
v_mfma_f32_32x32x16_bf16 v[80:95], v[24:27], v[172:175], v[80:95]
s_add_u32 m0, s33, 9216
ds_read_b64_tr_b16 v[20:21], v7 offset:12288
ds_read_b64_tr_b16 v[22:23], v7 offset:13312
buffer_load_dwordx4 v15, s[8:11], s52 offen lds
s_add_u32 s52, s52, 14336
s_waitcnt lgkmcnt(4)
v_mfma_f32_32x32x16_bf16 v[96:111], v[28:31], v[168:171], v[96:111]
buffer_load_dwordx4 v[160:163], v5, s[12:15], s53 offen sc1
s_add_u32 s53, s53, 1024
v_mfma_f32_32x32x16_bf16 v[112:127], v[28:31], v[172:175], v[112:127]
buffer_load_dwordx4 v[164:167], v5, s[12:15], s54 offen sc1
s_add_u32 s54, s54, 1024
buffer_load_dword v192, v193, s[44:47], s49 offen sc1
s_waitcnt vmcnt(22) lgkmcnt(2)
v_mfma_f32_32x32x16_bf16 v[64:79], v[16:19], v[176:179], v[64:79]
s_add_u32 m0, s33, 10240
ds_read_b64_tr_b16 v[24:25], v6 offset:14336
ds_read_b64_tr_b16 v[26:27], v6 offset:15360
buffer_load_dwordx4 v4, s[8:11], s52 offen lds
v_mfma_f32_32x32x16_bf16 v[80:95], v[16:19], v[180:183], v[80:95]
s_add_u32 m0, s33, 11264
ds_read_b64_tr_b16 v[28:29], v7 offset:14336
ds_read_b64_tr_b16 v[30:31], v7 offset:15360
buffer_load_dwordx4 v15, s[8:11], s52 offen lds
s_add_u32 s52, s52, 14336
s_waitcnt lgkmcnt(4)
v_mfma_f32_32x32x16_bf16 v[96:111], v[20:23], v[176:179], v[96:111]
buffer_load_dwordx4 v[168:171], v5, s[12:15], s53 offen sc1
s_add_u32 s53, s53, 1024
v_mfma_f32_32x32x16_bf16 v[112:127], v[20:23], v[180:183], v[112:127]
buffer_load_dwordx4 v[172:175], v5, s[12:15], s54 offen sc1
s_add_u32 s54, s54, 1024
s_waitcnt vmcnt(21) lgkmcnt(2)
v_mfma_f32_32x32x16_bf16 v[64:79], v[24:27], v[184:187], v[64:79]
s_add_u32 m0, s33, 12288
ds_read_b64_tr_b16 v[16:17], v6 offset:0
ds_read_b64_tr_b16 v[18:19], v6 offset:1024
buffer_load_dwordx4 v4, s[8:11], s52 offen lds
v_mfma_f32_32x32x16_bf16 v[80:95], v[24:27], v[188:191], v[80:95]
s_add_u32 m0, s33, 13312
ds_read_b64_tr_b16 v[20:21], v7 offset:0
ds_read_b64_tr_b16 v[22:23], v7 offset:1024
buffer_load_dwordx4 v15, s[8:11], s52 offen lds
s_add_u32 s52, s52, 14336
s_waitcnt lgkmcnt(4)
v_mfma_f32_32x32x16_bf16 v[96:111], v[28:31], v[184:187], v[96:111]
buffer_load_dwordx4 v[176:179], v5, s[12:15], s53 offen sc1
s_add_u32 s53, s53, 1024
v_mfma_f32_32x32x16_bf16 v[112:127], v[28:31], v[188:191], v[112:127]
buffer_load_dwordx4 v[180:183], v5, s[12:15], s54 offen sc1
s_add_u32 s54, s54, 1024
s_waitcnt vmcnt(21) lgkmcnt(2)
v_mfma_f32_32x32x16_bf16 v[64:79], v[16:19], v[128:131], v[64:79]
s_add_u32 m0, s33, 14336
ds_read_b64_tr_b16 v[24:25], v6 offset:2048
ds_read_b64_tr_b16 v[26:27], v6 offset:3072
buffer_load_dwordx4 v4, s[8:11], s52 offen lds
v_mfma_f32_32x32x16_bf16 v[80:95], v[16:19], v[132:135], v[80:95]
s_add_u32 m0, s33, 15360
ds_read_b64_tr_b16 v[28:29], v7 offset:2048
ds_read_b64_tr_b16 v[30:31], v7 offset:3072
buffer_load_dwordx4 v15, s[8:11], s52 offen lds
s_add_u32 s52, s52, 14336
s_waitcnt lgkmcnt(4)
v_mfma_f32_32x32x16_bf16 v[96:111], v[20:23], v[128:131], v[96:111]
buffer_load_dwordx4 v[184:187], v5, s[12:15], s53 offen sc1
s_add_u32 s53, s53, 1024
v_mfma_f32_32x32x16_bf16 v[112:127], v[20:23], v[132:135], v[112:127]
buffer_load_dwordx4 v[188:191], v5, s[12:15], s54 offen sc1
s_add_u32 s54, s54, 1024
s_waitcnt vmcnt(21) lgkmcnt(2)
v_mfma_f32_32x32x16_bf16 v[64:79], v[24:27], v[136:139], v[64:79]
s_add_u32 m0, s33, 0
ds_read_b64_tr_b16 v[16:17], v6 offset:4096
ds_read_b64_tr_b16 v[18:19], v6 offset:5120
buffer_load_dwordx4 v4, s[8:11], s52 offen lds
v_mfma_f32_32x32x16_bf16 v[80:95], v[24:27], v[140:143], v[80:95]
s_add_u32 m0, s33, 1024
ds_read_b64_tr_b16 v[20:21], v7 offset:4096
ds_read_b64_tr_b16 v[22:23], v7 offset:5120
buffer_load_dwordx4 v15, s[8:11], s52 offen lds
s_add_u32 s52, s52, 14336
s_waitcnt lgkmcnt(4)
v_mfma_f32_32x32x16_bf16 v[96:111], v[28:31], v[136:139], v[96:111]
buffer_load_dwordx4 v[128:131], v5, s[12:15], s53 offen sc1
s_add_u32 s53, s53, 1024
v_mfma_f32_32x32x16_bf16 v[112:127], v[28:31], v[140:143], v[112:127]
buffer_load_dwordx4 v[132:135], v5, s[12:15], s54 offen sc1
s_add_u32 s54, s54, 1024
s_waitcnt vmcnt(21) lgkmcnt(2)
v_mfma_f32_32x32x16_bf16 v[64:79], v[16:19], v[144:147], v[64:79]
s_add_u32 m0, s33, 2048
ds_read_b64_tr_b16 v[24:25], v6 offset:6144
ds_read_b64_tr_b16 v[26:27], v6 offset:7168
buffer_load_dwordx4 v4, s[8:11], s52 offen lds
v_mfma_f32_32x32x16_bf16 v[80:95], v[16:19], v[148:151], v[80:95]
s_add_u32 m0, s33, 3072
ds_read_b64_tr_b16 v[28:29], v7 offset:6144
ds_read_b64_tr_b16 v[30:31], v7 offset:7168
buffer_load_dwordx4 v15, s[8:11], s52 offen lds
s_add_u32 s52, s52, 14336
s_waitcnt lgkmcnt(4)
v_mfma_f32_32x32x16_bf16 v[96:111], v[20:23], v[144:147], v[96:111]
buffer_load_dwordx4 v[136:139], v5, s[12:15], s53 offen sc1
s_add_u32 s53, s53, 1024
v_mfma_f32_32x32x16_bf16 v[112:127], v[20:23], v[148:151], v[112:127]
buffer_load_dwordx4 v[140:143], v5, s[12:15], s54 offen sc1
s_add_u32 s54, s54, 1024
s_waitcnt vmcnt(21) lgkmcnt(2)
v_mfma_f32_32x32x16_bf16 v[64:79], v[24:27], v[152:155], v[64:79]
s_add_u32 m0, s33, 4096
ds_read_b64_tr_b16 v[16:17], v6 offset:8192
ds_read_b64_tr_b16 v[18:19], v6 offset:9216
buffer_load_dwordx4 v4, s[8:11], s52 offen lds
v_mfma_f32_32x32x16_bf16 v[80:95], v[24:27], v[156:159], v[80:95]
s_add_u32 m0, s33, 5120
ds_read_b64_tr_b16 v[20:21], v7 offset:8192
ds_read_b64_tr_b16 v[22:23], v7 offset:9216
buffer_load_dwordx4 v15, s[8:11], s52 offen lds
s_add_u32 s52, s52, 14336
s_waitcnt lgkmcnt(4)
v_mfma_f32_32x32x16_bf16 v[96:111], v[28:31], v[152:155], v[96:111]
buffer_load_dwordx4 v[144:147], v5, s[12:15], s53 offen sc1
s_add_u32 s53, s53, 1024
v_mfma_f32_32x32x16_bf16 v[112:127], v[28:31], v[156:159], v[112:127]
buffer_load_dwordx4 v[148:151], v5, s[12:15], s54 offen sc1
s_add_u32 s54, s54, 1024
s_waitcnt vmcnt(20) lgkmcnt(2)
v_mfma_f32_32x32x16_bf16 v[64:79], v[16:19], v[160:163], v[64:79]
s_add_u32 m0, s33, 6144
ds_read_b64_tr_b16 v[24:25], v6 offset:10240
ds_read_b64_tr_b16 v[26:27], v6 offset:11264
buffer_load_dwordx4 v4, s[8:11], s52 offen lds
v_mfma_f32_32x32x16_bf16 v[80:95], v[16:19], v[164:167], v[80:95]
s_add_u32 m0, s33, 7168
ds_read_b64_tr_b16 v[28:29], v7 offset:10240
ds_read_b64_tr_b16 v[30:31], v7 offset:11264
buffer_load_dwordx4 v15, s[8:11], s52 offen lds
s_add_u32 s52, s52, 14336
s_waitcnt lgkmcnt(4)
v_mfma_f32_32x32x16_bf16 v[96:111], v[20:23], v[160:163], v[96:111]
buffer_load_dwordx4 v[152:155], v5, s[12:15], s53 offen sc1
s_add_u32 s53, s53, 1024
v_mfma_f32_32x32x16_bf16 v[112:127], v[20:23], v[164:167], v[112:127]
buffer_load_dwordx4 v[156:159], v5, s[12:15], s54 offen sc1
s_add_u32 s54, s54, 1024
v_cmp_ne_u32 vcc, s69, v192
s_cbranch_vccz L_es_11_d
s_mov_b32 s61, 20000
L_es_11:
buffer_load_dword v192, v193, s[44:47], s49 offen sc1
s_sub_u32 s61, s61, 1
s_cbranch_scc1 L_es_11_d
s_waitcnt vmcnt(0)
v_cmp_ne_u32 vcc, s69, v192
s_cbranch_vccnz L_es_11
L_es_11_d:

s_add_u32 s51, s48, 0
buffer_load_dword v196, v11, s[16:19], s51 offen sc1
s_add_u32 s51, s48, 4096
buffer_load_dword v197, v11, s[16:19], s51 offen sc1
s_add_u32 s51, s48, 8192
buffer_load_dword v198, v11, s[16:19], s51 offen sc1
s_add_u32 s51, s48, 12288
buffer_load_dword v199, v11, s[16:19], s51 offen sc1
s_add_u32 s51, s48, 32768
buffer_load_dword v200, v11, s[16:19], s51 offen sc1
s_add_u32 s51, s48, 36864
buffer_load_dword v201, v11, s[16:19], s51 offen sc1
s_add_u32 s51, s48, 40960
buffer_load_dword v202, v11, s[16:19], s51 offen sc1
s_add_u32 s51, s48, 45056
buffer_load_dword v203, v11, s[16:19], s51 offen sc1
s_add_u32 s51, s48, 65536
buffer_load_dword v204, v11, s[16:19], s51 offen sc1
s_add_u32 s51, s48, 69632
buffer_load_dword v205, v11, s[16:19], s51 offen sc1
s_add_u32 s51, s48, 73728
buffer_load_dword v206, v11, s[16:19], s51 offen sc1
s_add_u32 s51, s48, 77824
buffer_load_dword v207, v11, s[16:19], s51 offen sc1
s_add_u32 s51, s48, 98304
buffer_load_dword v208, v11, s[16:19], s51 offen sc1
s_add_u32 s51, s48, 102400
buffer_load_dword v209, v11, s[16:19], s51 offen sc1
s_add_u32 s51, s48, 106496
buffer_load_dword v210, v11, s[16:19], s51 offen sc1
s_add_u32 s51, s48, 110592
buffer_load_dword v211, v11, s[16:19], s51 offen sc1
buffer_load_dwordx2 v[212:213], v14, s[4:7], s50 offen offset:0
buffer_load_dwordx2 v[214:215], v14, s[4:7], s50 offen offset:16
buffer_load_dwordx2 v[216:217], v14, s[4:7], s50 offen offset:32
buffer_load_dwordx2 v[218:219], v14, s[4:7], s50 offen offset:48
s_waitcnt vmcnt(40) lgkmcnt(2)
v_mfma_f32_32x32x16_bf16 v[64:79], v[24:27], v[168:171], v[64:79]
ds_read_b64_tr_b16 v[16:17], v6 offset:12288
ds_read_b64_tr_b16 v[18:19], v6 offset:13312
v_mfma_f32_32x32x16_bf16 v[80:95], v[24:27], v[172:175], v[80:95]
ds_read_b64_tr_b16 v[20:21], v7 offset:12288
ds_read_b64_tr_b16 v[22:23], v7 offset:13312
s_waitcnt lgkmcnt(4)
v_mfma_f32_32x32x16_bf16 v[96:111], v[28:31], v[168:171], v[96:111]
v_mfma_f32_32x32x16_bf16 v[112:127], v[28:31], v[172:175], v[112:127]
s_waitcnt vmcnt(36) lgkmcnt(2)
v_mfma_f32_32x32x16_bf16 v[64:79], v[16:19], v[176:179], v[64:79]
ds_read_b64_tr_b16 v[24:25], v6 offset:14336
ds_read_b64_tr_b16 v[26:27], v6 offset:15360
v_mfma_f32_32x32x16_bf16 v[80:95], v[16:19], v[180:183], v[80:95]
ds_read_b64_tr_b16 v[28:29], v7 offset:14336
ds_read_b64_tr_b16 v[30:31], v7 offset:15360
s_waitcnt lgkmcnt(4)
v_mfma_f32_32x32x16_bf16 v[96:111], v[20:23], v[176:179], v[96:111]
v_mfma_f32_32x32x16_bf16 v[112:127], v[20:23], v[180:183], v[112:127]
s_waitcnt vmcnt(32) lgkmcnt(2)
v_mfma_f32_32x32x16_bf16 v[64:79], v[24:27], v[184:187], v[64:79]
ds_read_b64_tr_b16 v[16:17], v6 offset:0
ds_read_b64_tr_b16 v[18:19], v6 offset:1024
v_mfma_f32_32x32x16_bf16 v[80:95], v[24:27], v[188:191], v[80:95]
ds_read_b64_tr_b16 v[20:21], v7 offset:0
ds_read_b64_tr_b16 v[22:23], v7 offset:1024
s_waitcnt lgkmcnt(4)
v_mfma_f32_32x32x16_bf16 v[96:111], v[28:31], v[184:187], v[96:111]
v_mfma_f32_32x32x16_bf16 v[112:127], v[28:31], v[188:191], v[112:127]
s_waitcnt vmcnt(28) lgkmcnt(2)
v_mfma_f32_32x32x16_bf16 v[64:79], v[16:19], v[128:131], v[64:79]
ds_read_b64_tr_b16 v[24:25], v6 offset:2048
ds_read_b64_tr_b16 v[26:27], v6 offset:3072
v_mfma_f32_32x32x16_bf16 v[80:95], v[16:19], v[132:135], v[80:95]
ds_read_b64_tr_b16 v[28:29], v7 offset:2048
ds_read_b64_tr_b16 v[30:31], v7 offset:3072
s_waitcnt lgkmcnt(4)
v_mfma_f32_32x32x16_bf16 v[96:111], v[20:23], v[128:131], v[96:111]
v_mfma_f32_32x32x16_bf16 v[112:127], v[20:23], v[132:135], v[112:127]
s_waitcnt vmcnt(24) lgkmcnt(2)
v_mfma_f32_32x32x16_bf16 v[64:79], v[24:27], v[136:139], v[64:79]
ds_read_b64_tr_b16 v[16:17], v6 offset:4096
ds_read_b64_tr_b16 v[18:19], v6 offset:5120
v_mfma_f32_32x32x16_bf16 v[80:95], v[24:27], v[140:143], v[80:95]
ds_read_b64_tr_b16 v[20:21], v7 offset:4096
ds_read_b64_tr_b16 v[22:23], v7 offset:5120
s_waitcnt lgkmcnt(4)
v_mfma_f32_32x32x16_bf16 v[96:111], v[28:31], v[136:139], v[96:111]
v_mfma_f32_32x32x16_bf16 v[112:127], v[28:31], v[140:143], v[112:127]
s_waitcnt vmcnt(20) lgkmcnt(2)
v_mfma_f32_32x32x16_bf16 v[64:79], v[16:19], v[144:147], v[64:79]
ds_read_b64_tr_b16 v[24:25], v6 offset:6144
ds_read_b64_tr_b16 v[26:27], v6 offset:7168
v_mfma_f32_32x32x16_bf16 v[80:95], v[16:19], v[148:151], v[80:95]
ds_read_b64_tr_b16 v[28:29], v7 offset:6144
ds_read_b64_tr_b16 v[30:31], v7 offset:7168
s_waitcnt lgkmcnt(4)
v_mfma_f32_32x32x16_bf16 v[96:111], v[20:23], v[144:147], v[96:111]
v_mfma_f32_32x32x16_bf16 v[112:127], v[20:23], v[148:151], v[112:127]
s_waitcnt lgkmcnt(2)
v_mfma_f32_32x32x16_bf16 v[64:79], v[24:27], v[152:155], v[64:79]
v_mfma_f32_32x32x16_bf16 v[80:95], v[24:27], v[156:159], v[80:95]
s_waitcnt lgkmcnt(0)
v_mfma_f32_32x32x16_bf16 v[96:111], v[28:31], v[152:155], v[96:111]
v_mfma_f32_32x32x16_bf16 v[112:127], v[28:31], v[156:159], v[112:127]
v_lshlrev_b32 v8, 4, v2
v_add_u32 v9, s33, v8
s_lshl_b32 s31, s24, 12
v_add_u32 v8, s31, v8
s_mov_b32 s52, 3216550459
s_mov_b32 s53, 3216550459
s_mov_b32 s54, 1.0
s_mov_b32 s55, 1.0
v_and_b32 v10, 1, v2
v_lshlrev_b32 v10, 4, v10
v_sub_u32 v10, 16, v10
s_nop 7

s_cmp_eq_u32 s24, 0
s_cbranch_scc1 L_qx_12
ds_write_b128 v9, v[64:67] offset:0
ds_write_b128 v9, v[68:71] offset:1024
ds_write_b128 v9, v[72:75] offset:2048
ds_write_b128 v9, v[76:79] offset:3072
s_branch L_qy_13
L_qx_12:
v_mov_b32 v16, v64
v_mov_b32 v17, v65
v_mov_b32 v18, v66
v_mov_b32 v19, v67
v_mov_b32 v20, v68
v_mov_b32 v21, v69
v_mov_b32 v22, v70
v_mov_b32 v23, v71
v_mov_b32 v24, v72
v_mov_b32 v25, v73
v_mov_b32 v26, v74
v_mov_b32 v27, v75
v_mov_b32 v28, v76
v_mov_b32 v29, v77
v_mov_b32 v30, v78
v_mov_b32 v31, v79
L_qy_13:
s_cmp_eq_u32 s24, 1
s_cbranch_scc1 L_qx_14
ds_write_b128 v9, v[80:83] offset:4096
ds_write_b128 v9, v[84:87] offset:5120
ds_write_b128 v9, v[88:91] offset:6144
ds_write_b128 v9, v[92:95] offset:7168
s_branch L_qy_15
L_qx_14:
v_mov_b32 v16, v80
v_mov_b32 v17, v81
v_mov_b32 v18, v82
v_mov_b32 v19, v83
v_mov_b32 v20, v84
v_mov_b32 v21, v85
v_mov_b32 v22, v86
v_mov_b32 v23, v87
v_mov_b32 v24, v88
v_mov_b32 v25, v89
v_mov_b32 v26, v90
v_mov_b32 v27, v91
v_mov_b32 v28, v92
v_mov_b32 v29, v93
v_mov_b32 v30, v94
v_mov_b32 v31, v95
L_qy_15:
s_cmp_eq_u32 s24, 2
s_cbranch_scc1 L_qx_16
ds_write_b128 v9, v[96:99] offset:8192
ds_write_b128 v9, v[100:103] offset:9216
ds_write_b128 v9, v[104:107] offset:10240
ds_write_b128 v9, v[108:111] offset:11264
s_branch L_qy_17
L_qx_16:
v_mov_b32 v16, v96
v_mov_b32 v17, v97
v_mov_b32 v18, v98
v_mov_b32 v19, v99
v_mov_b32 v20, v100
v_mov_b32 v21, v101
v_mov_b32 v22, v102
v_mov_b32 v23, v103
v_mov_b32 v24, v104
v_mov_b32 v25, v105
v_mov_b32 v26, v106
v_mov_b32 v27, v107
v_mov_b32 v28, v108
v_mov_b32 v29, v109
v_mov_b32 v30, v110
v_mov_b32 v31, v111
L_qy_17:
s_cmp_eq_u32 s24, 3
s_cbranch_scc1 L_qx_18
ds_write_b128 v9, v[112:115] offset:12288
ds_write_b128 v9, v[116:119] offset:13312
ds_write_b128 v9, v[120:123] offset:14336
ds_write_b128 v9, v[124:127] offset:15360
s_branch L_qy_19
L_qx_18:
v_mov_b32 v16, v112
v_mov_b32 v17, v113
v_mov_b32 v18, v114
v_mov_b32 v19, v115
v_mov_b32 v20, v116
v_mov_b32 v21, v117
v_mov_b32 v22, v118
v_mov_b32 v23, v119
v_mov_b32 v24, v120
v_mov_b32 v25, v121
v_mov_b32 v26, v122
v_mov_b32 v27, v123
v_mov_b32 v28, v124
v_mov_b32 v29, v125
v_mov_b32 v30, v126
v_mov_b32 v31, v127
L_qy_19:
s_add_u32 s31, s24, 1
s_and_b32 s31, s31, 3
s_lshl_b32 s31, s31, 14
v_add_u32 v5, s31, v8
s_add_u32 s31, s24, 2
s_and_b32 s31, s31, 3
s_lshl_b32 s31, s31, 14
v_add_u32 v6, s31, v8
s_add_u32 s31, s24, 3
s_and_b32 s31, s31, 3
s_lshl_b32 s31, s31, 14
v_add_u32 v7, s31, v8
s_waitcnt lgkmcnt(0)
s_barrier
ds_read_b128 v[64:67], v5 offset:0
ds_read_b128 v[68:71], v5 offset:1024
ds_read_b128 v[72:75], v5 offset:2048
ds_read_b128 v[76:79], v5 offset:3072
ds_read_b128 v[80:83], v6 offset:0
ds_read_b128 v[84:87], v6 offset:1024
ds_read_b128 v[88:91], v6 offset:2048
ds_read_b128 v[92:95], v6 offset:3072
ds_read_b128 v[96:99], v7 offset:0
ds_read_b128 v[100:103], v7 offset:1024
ds_read_b128 v[104:107], v7 offset:2048
ds_read_b128 v[108:111], v7 offset:3072
s_waitcnt vmcnt(0)
v_lshlrev_b32 v196, v10, v196
v_lshlrev_b32 v197, v10, v197
v_lshlrev_b32 v198, v10, v198
v_lshlrev_b32 v199, v10, v199
v_lshlrev_b32 v200, v10, v200
v_lshlrev_b32 v201, v10, v201
v_lshlrev_b32 v202, v10, v202
v_lshlrev_b32 v203, v10, v203
v_lshlrev_b32 v204, v10, v204
v_lshlrev_b32 v205, v10, v205
v_lshlrev_b32 v206, v10, v206
v_lshlrev_b32 v207, v10, v207
v_lshlrev_b32 v208, v10, v208
v_lshlrev_b32 v209, v10, v209
v_lshlrev_b32 v210, v10, v210
v_lshlrev_b32 v211, v10, v211
v_and_b32 v196, 0xffff0000, v196
v_and_b32 v197, 0xffff0000, v197
v_and_b32 v198, 0xffff0000, v198
v_and_b32 v199, 0xffff0000, v199
v_and_b32 v200, 0xffff0000, v200
v_and_b32 v201, 0xffff0000, v201
v_and_b32 v202, 0xffff0000, v202
v_and_b32 v203, 0xffff0000, v203
v_and_b32 v204, 0xffff0000, v204
v_and_b32 v205, 0xffff0000, v205
v_and_b32 v206, 0xffff0000, v206
v_and_b32 v207, 0xffff0000, v207
v_and_b32 v208, 0xffff0000, v208
v_and_b32 v209, 0xffff0000, v209
v_and_b32 v210, 0xffff0000, v210
v_and_b32 v211, 0xffff0000, v211
s_waitcnt lgkmcnt(8)
v_pk_add_f32 v[16:17], v[16:17], v[64:65]
v_pk_add_f32 v[18:19], v[18:19], v[66:67]
v_pk_add_f32 v[20:21], v[20:21], v[68:69]
v_pk_add_f32 v[22:23], v[22:23], v[70:71]
v_pk_add_f32 v[24:25], v[24:25], v[72:73]
v_pk_add_f32 v[26:27], v[26:27], v[74:75]
v_pk_add_f32 v[28:29], v[28:29], v[76:77]
v_pk_add_f32 v[30:31], v[30:31], v[78:79]
s_waitcnt lgkmcnt(0)
v_pk_add_f32 v[80:81], v[80:81], v[96:97]
v_pk_add_f32 v[82:83], v[82:83], v[98:99]
v_pk_add_f32 v[84:85], v[84:85], v[100:101]
v_pk_add_f32 v[86:87], v[86:87], v[102:103]
v_pk_add_f32 v[88:89], v[88:89], v[104:105]
v_pk_add_f32 v[90:91], v[90:91], v[106:107]
v_pk_add_f32 v[92:93], v[92:93], v[108:109]
v_pk_add_f32 v[94:95], v[94:95], v[110:111]
v_pk_add_f32 v[16:17], v[16:17], v[80:81]
v_pk_add_f32 v[18:19], v[18:19], v[82:83]
v_pk_add_f32 v[20:21], v[20:21], v[84:85]
v_pk_add_f32 v[22:23], v[22:23], v[86:87]
v_pk_add_f32 v[24:25], v[24:25], v[88:89]
v_pk_add_f32 v[26:27], v[26:27], v[90:91]
v_pk_add_f32 v[28:29], v[28:29], v[92:93]
v_pk_add_f32 v[30:31], v[30:31], v[94:95]
v_cvt_pk_bf16_f32 v64, v16, v17
v_cvt_pk_bf16_f32 v66, v18, v19
v_cvt_pk_bf16_f32 v68, v20, v21
v_cvt_pk_bf16_f32 v70, v22, v23
v_cvt_pk_bf16_f32 v72, v24, v25
v_cvt_pk_bf16_f32 v74, v26, v27
v_cvt_pk_bf16_f32 v76, v28, v29
v_cvt_pk_bf16_f32 v78, v30, v31
v_lshlrev_b32 v16, 16, v64
v_and_b32 v17, 0xffff0000, v64
v_lshlrev_b32 v18, 16, v66
v_and_b32 v19, 0xffff0000, v66
v_lshlrev_b32 v20, 16, v68
v_and_b32 v21, 0xffff0000, v68
v_lshlrev_b32 v22, 16, v70
v_and_b32 v23, 0xffff0000, v70
v_lshlrev_b32 v24, 16, v72
v_and_b32 v25, 0xffff0000, v72
v_lshlrev_b32 v26, 16, v74
v_and_b32 v27, 0xffff0000, v74
v_lshlrev_b32 v28, 16, v76
v_and_b32 v29, 0xffff0000, v76
v_lshlrev_b32 v30, 16, v78
v_and_b32 v31, 0xffff0000, v78
v_pk_mul_f32 v[64:65], v[16:17], s[52:53]
v_pk_mul_f32 v[66:67], v[18:19], s[52:53]
v_pk_mul_f32 v[68:69], v[20:21], s[52:53]
v_pk_mul_f32 v[70:71], v[22:23], s[52:53]
v_pk_mul_f32 v[72:73], v[24:25], s[52:53]
v_pk_mul_f32 v[74:75], v[26:27], s[52:53]
v_pk_mul_f32 v[76:77], v[28:29], s[52:53]
v_pk_mul_f32 v[78:79], v[30:31], s[52:53]
v_exp_f32 v64, v64
v_exp_f32 v65, v65
v_exp_f32 v66, v66
v_exp_f32 v67, v67
v_exp_f32 v68, v68
v_exp_f32 v69, v69
v_exp_f32 v70, v70
v_exp_f32 v71, v71
v_exp_f32 v72, v72
v_exp_f32 v73, v73
v_exp_f32 v74, v74
v_exp_f32 v75, v75
v_exp_f32 v76, v76
v_exp_f32 v77, v77
v_exp_f32 v78, v78
v_exp_f32 v79, v79
v_pk_add_f32 v[64:65], v[64:65], s[54:55]
v_pk_add_f32 v[66:67], v[66:67], s[54:55]
v_pk_add_f32 v[68:69], v[68:69], s[54:55]
v_pk_add_f32 v[70:71], v[70:71], s[54:55]
v_pk_add_f32 v[72:73], v[72:73], s[54:55]
v_pk_add_f32 v[74:75], v[74:75], s[54:55]
v_pk_add_f32 v[76:77], v[76:77], s[54:55]
v_pk_add_f32 v[78:79], v[78:79], s[54:55]
v_rcp_f32 v64, v64
v_rcp_f32 v65, v65
v_rcp_f32 v66, v66
v_rcp_f32 v67, v67
v_rcp_f32 v68, v68
v_rcp_f32 v69, v69
v_rcp_f32 v70, v70
v_rcp_f32 v71, v71
v_rcp_f32 v72, v72
v_rcp_f32 v73, v73
v_rcp_f32 v74, v74
v_rcp_f32 v75, v75
v_rcp_f32 v76, v76
v_rcp_f32 v77, v77
v_rcp_f32 v78, v78
v_rcp_f32 v79, v79
v_pk_mul_f32 v[16:17], v[16:17], v[64:65]
v_pk_mul_f32 v[18:19], v[18:19], v[66:67]
v_pk_mul_f32 v[20:21], v[20:21], v[68:69]
v_pk_mul_f32 v[22:23], v[22:23], v[70:71]
v_pk_mul_f32 v[24:25], v[24:25], v[72:73]
v_pk_mul_f32 v[26:27], v[26:27], v[74:75]
v_pk_mul_f32 v[28:29], v[28:29], v[76:77]
v_pk_mul_f32 v[30:31], v[30:31], v[78:79]
v_cvt_pk_bf16_f32 v64, v16, v17
v_cvt_pk_bf16_f32 v66, v18, v19
v_cvt_pk_bf16_f32 v68, v20, v21
v_cvt_pk_bf16_f32 v70, v22, v23
v_cvt_pk_bf16_f32 v72, v24, v25
v_cvt_pk_bf16_f32 v74, v26, v27
v_cvt_pk_bf16_f32 v76, v28, v29
v_cvt_pk_bf16_f32 v78, v30, v31
v_lshlrev_b32 v16, 16, v64
v_and_b32 v17, 0xffff0000, v64
v_lshlrev_b32 v18, 16, v66
v_and_b32 v19, 0xffff0000, v66
v_lshlrev_b32 v20, 16, v68
v_and_b32 v21, 0xffff0000, v68
v_lshlrev_b32 v22, 16, v70
v_and_b32 v23, 0xffff0000, v70
v_lshlrev_b32 v24, 16, v72
v_and_b32 v25, 0xffff0000, v72
v_lshlrev_b32 v26, 16, v74
v_and_b32 v27, 0xffff0000, v74
v_lshlrev_b32 v28, 16, v76
v_and_b32 v29, 0xffff0000, v76
v_lshlrev_b32 v30, 16, v78
v_and_b32 v31, 0xffff0000, v78
v_pk_mul_f32 v[16:17], v[16:17], v[196:197]
v_pk_mul_f32 v[18:19], v[18:19], v[198:199]
v_pk_mul_f32 v[20:21], v[20:21], v[200:201]
v_pk_mul_f32 v[22:23], v[22:23], v[202:203]
v_pk_mul_f32 v[24:25], v[24:25], v[204:205]
v_pk_mul_f32 v[26:27], v[26:27], v[206:207]
v_pk_mul_f32 v[28:29], v[28:29], v[208:209]
v_pk_mul_f32 v[30:31], v[30:31], v[210:211]
v_cvt_pk_bf16_f32 v64, v16, v17
v_cvt_pk_bf16_f32 v66, v18, v19
v_cvt_pk_bf16_f32 v68, v20, v21
v_cvt_pk_bf16_f32 v70, v22, v23
v_cvt_pk_bf16_f32 v72, v24, v25
v_cvt_pk_bf16_f32 v74, v26, v27
v_cvt_pk_bf16_f32 v76, v28, v29
v_cvt_pk_bf16_f32 v78, v30, v31
v_lshlrev_b32 v16, 16, v64
v_and_b32 v17, 0xffff0000, v64
v_lshlrev_b32 v18, 16, v66
v_and_b32 v19, 0xffff0000, v66
v_lshlrev_b32 v20, 16, v68
v_and_b32 v21, 0xffff0000, v68
v_lshlrev_b32 v22, 16, v70
v_and_b32 v23, 0xffff0000, v70
v_lshlrev_b32 v24, 16, v72
v_and_b32 v25, 0xffff0000, v72
v_lshlrev_b32 v26, 16, v74
v_and_b32 v27, 0xffff0000, v74
v_lshlrev_b32 v28, 16, v76
v_and_b32 v29, 0xffff0000, v76
v_lshlrev_b32 v30, 16, v78
v_and_b32 v31, 0xffff0000, v78
v_lshlrev_b32 v64, 16, v212
v_and_b32 v65, 0xffff0000, v212
v_lshlrev_b32 v66, 16, v213
v_and_b32 v67, 0xffff0000, v213
v_lshlrev_b32 v68, 16, v214
v_and_b32 v69, 0xffff0000, v214
v_lshlrev_b32 v70, 16, v215
v_and_b32 v71, 0xffff0000, v215
v_lshlrev_b32 v72, 16, v216
v_and_b32 v73, 0xffff0000, v216
v_lshlrev_b32 v74, 16, v217
v_and_b32 v75, 0xffff0000, v217
v_lshlrev_b32 v76, 16, v218
v_and_b32 v77, 0xffff0000, v218
v_lshlrev_b32 v78, 16, v219
v_and_b32 v79, 0xffff0000, v219
v_pk_add_f32 v[16:17], v[16:17], v[64:65]
v_pk_add_f32 v[18:19], v[18:19], v[66:67]
v_pk_add_f32 v[20:21], v[20:21], v[68:69]
v_pk_add_f32 v[22:23], v[22:23], v[70:71]
v_pk_add_f32 v[24:25], v[24:25], v[72:73]
v_pk_add_f32 v[26:27], v[26:27], v[74:75]
v_pk_add_f32 v[28:29], v[28:29], v[76:77]
v_pk_add_f32 v[30:31], v[30:31], v[78:79]
v_cvt_pk_bf16_f32 v64, v16, v17
v_cvt_pk_bf16_f32 v65, v18, v19
buffer_store_dwordx2 v[64:65], v14, s[20:23], s50 offen offset:0
v_cvt_pk_bf16_f32 v66, v20, v21
v_cvt_pk_bf16_f32 v67, v22, v23
buffer_store_dwordx2 v[66:67], v14, s[20:23], s50 offen offset:16
v_cvt_pk_bf16_f32 v68, v24, v25
v_cvt_pk_bf16_f32 v69, v26, v27
buffer_store_dwordx2 v[68:69], v14, s[20:23], s50 offen offset:32
v_cvt_pk_bf16_f32 v70, v28, v29
v_cvt_pk_bf16_f32 v71, v30, v31
buffer_store_dwordx2 v[70:71], v14, s[20:23], s50 offen offset:48
s_add_u32 s2, s2, 64
s_branch L_fin
L_typeA:
s_sub_u32 s2, s2, 288
s_setprio 3
s_load_dwordx4 s[36:39], s[0:1], 8
s_load_dwordx4 s[40:43], s[0:1], 24
s_load_dwordx4 s[44:47], s[0:1], 40
s_load_dwordx2 s[48:49], s[0:1], 104
v_lshrrev_b32 v1, 6, v0
v_and_b32 v2, 63, v0
s_mov_b32 s25, s2
s_mov_b32 s60, 1069066811
v_readfirstlane_b32 s24, v1
v_lshlrev_b32 v3, 1, v0
s_waitcnt lgkmcnt(0)

s_mov_b32 s4, s36
s_mov_b32 s5, s37
s_mov_b32 s6, 229376
s_mov_b32 s7, 0x20000
s_mov_b32 s8, s38
s_mov_b32 s9, s39
s_mov_b32 s10, 229376
s_mov_b32 s11, 0x20000
s_mov_b32 s12, s40
s_mov_b32 s13, s41
s_mov_b32 s14, 229376
s_mov_b32 s15, 0x20000
s_mov_b32 s16, s42
s_mov_b32 s17, s43
s_mov_b32 s18, 229376
s_mov_b32 s19, 0x20000
s_mov_b32 s20, s44
s_mov_b32 s21, s45
s_mov_b32 s22, 896
s_mov_b32 s23, 0x20000
s_mov_b32 s28, s46
s_mov_b32 s29, s47
s_mov_b32 s30, 896
s_mov_b32 s31, 0x20000
s_lshl_b32 s26, s25, 10
s_lshl_b32 s27, s25, 2
v_mov_b32 v4, 0
s_add_u32 s50, s26, 0
s_add_u32 s51, s27, 0
buffer_load_ushort v8, v3, s[4:7], s50 offen
buffer_load_ushort v9, v3, s[8:11], s50 offen
buffer_load_ushort v10, v3, s[12:15], s50 offen
buffer_load_ushort v11, v3, s[16:19], s50 offen
buffer_load_ushort v12, v4, s[20:23], s51 offen
buffer_load_ushort v13, v4, s[28:31], s51 offen

s_add_u32 s50, s26, 512
s_add_u32 s51, s27, 2
buffer_load_ushort v16, v3, s[4:7], s50 offen
buffer_load_ushort v17, v3, s[8:11], s50 offen
buffer_load_ushort v18, v3, s[12:15], s50 offen
buffer_load_ushort v19, v3, s[16:19], s50 offen
buffer_load_ushort v20, v4, s[20:23], s51 offen
buffer_load_ushort v21, v4, s[28:31], s51 offen

v_lshlrev_b32 v5, 3, v0
v_sub_u32 v5, 2049, v5
v_mov_b32 v6, 4096
v_subrev_u32 v42, 0, v5
v_subrev_u32 v44, 1, v5
v_subrev_u32 v46, 2, v5
v_subrev_u32 v48, 3, v5
v_subrev_u32 v50, 4, v5
v_subrev_u32 v52, 5, v5
v_subrev_u32 v54, 6, v5
v_subrev_u32 v56, 7, v5
v_subrev_u32 v58, 8, v5
v_min_i32 v42, 2047, v42
v_min_i32 v44, 2047, v44
v_cvt_f32_u32 v46, v46
v_cvt_f32_u32 v48, v48
v_cvt_f32_u32 v50, v50
v_cvt_f32_u32 v52, v52
v_cvt_f32_u32 v54, v54
v_cvt_f32_u32 v56, v56
v_cvt_f32_u32 v58, v58
v_cvt_f32_u32 v42, v42
v_cvt_f32_u32 v44, v44
v_cvt_pk_bf16_f32 v46, v46, v46
v_cvt_pk_bf16_f32 v48, v48, v48
v_cvt_pk_bf16_f32 v50, v50, v50
v_cvt_pk_bf16_f32 v52, v52, v52
v_cvt_pk_bf16_f32 v54, v54, v54
v_cvt_pk_bf16_f32 v56, v56, v56
v_cvt_pk_bf16_f32 v58, v58, v58
v_cvt_pk_bf16_f32 v42, v42, v42
v_cvt_pk_bf16_f32 v44, v44, v44
v_lshlrev_b32 v46, 16, v46
v_lshlrev_b32 v48, 16, v48
v_lshlrev_b32 v50, 16, v50
v_lshlrev_b32 v52, 16, v52
v_lshlrev_b32 v54, 16, v54
v_lshlrev_b32 v56, 16, v56
v_lshlrev_b32 v58, 16, v58
v_lshlrev_b32 v42, 16, v42
v_lshlrev_b32 v44, 16, v44
v_cvt_u32_f32 v46, v46
v_cvt_u32_f32 v48, v48
v_cvt_u32_f32 v50, v50
v_cvt_u32_f32 v52, v52
v_cvt_u32_f32 v54, v54
v_cvt_u32_f32 v56, v56
v_cvt_u32_f32 v58, v58
v_cvt_u32_f32 v42, v42
v_cvt_u32_f32 v44, v44
v_lshrrev_b32 v26, 8, v46
v_lshrrev_b32 v27, 8, v48
v_lshrrev_b32 v28, 8, v50
v_lshrrev_b32 v29, 8, v52
v_lshrrev_b32 v30, 8, v54
v_lshrrev_b32 v31, 8, v56
v_lshrrev_b32 v32, 8, v58
v_lshrrev_b32 v24, 8, v42
v_lshrrev_b32 v25, 8, v44
v_and_b32 v47, 7, v46
v_and_b32 v49, 7, v48
v_and_b32 v51, 7, v50
v_and_b32 v53, 7, v52
v_and_b32 v55, 7, v54
v_and_b32 v57, 7, v56
v_and_b32 v59, 7, v58
v_and_b32 v43, 7, v42
v_and_b32 v45, 7, v44
v_lshl_add_u32 v26, v26, 10, v6
v_lshl_add_u32 v27, v27, 10, v6
v_lshl_add_u32 v28, v28, 10, v6
v_lshl_add_u32 v29, v29, 10, v6
v_lshl_add_u32 v30, v30, 10, v6
v_lshl_add_u32 v31, v31, 10, v6
v_lshl_add_u32 v32, v32, 10, v6
v_lshl_add_u32 v24, v24, 10, v6
v_lshl_add_u32 v25, v25, 10, v6
v_bfe_u32 v46, v46, 3, 5
v_bfe_u32 v48, v48, 3, 5
v_bfe_u32 v50, v50, 3, 5
v_bfe_u32 v52, v52, 3, 5
v_bfe_u32 v54, v54, 3, 5
v_bfe_u32 v56, v56, 3, 5
v_bfe_u32 v58, v58, 3, 5
v_bfe_u32 v42, v42, 3, 5
v_bfe_u32 v44, v44, 3, 5
v_lshl_add_u32 v26, v47, 7, v26
v_lshl_add_u32 v27, v49, 7, v27
v_lshl_add_u32 v28, v51, 7, v28
v_lshl_add_u32 v29, v53, 7, v29
v_lshl_add_u32 v30, v55, 7, v30
v_lshl_add_u32 v31, v57, 7, v31
v_lshl_add_u32 v32, v59, 7, v32
v_lshl_add_u32 v24, v43, 7, v24
v_lshl_add_u32 v25, v45, 7, v25
v_lshl_add_u32 v26, v46, 2, v26
v_lshl_add_u32 v27, v48, 2, v27
v_lshl_add_u32 v28, v50, 2, v28
v_lshl_add_u32 v29, v52, 2, v29
v_lshl_add_u32 v30, v54, 2, v30
v_lshl_add_u32 v31, v56, 2, v31
v_lshl_add_u32 v32, v58, 2, v32
v_lshl_add_u32 v24, v42, 2, v24
v_lshl_add_u32 v25, v44, 2, v25
v_mov_b32 v35, 12416
v_cmp_eq_u32 vcc, 0, v0
v_mov_b32 v5, 4224
v_mov_b32 v7, 4096
v_cndmask_b32 v33, v35, v5, vcc
v_cndmask_b32 v34, v35, v7, vcc

v_mov_b32 v36, 12416
v_mov_b32 v37, 12416
v_mov_b32 v38, 12416
v_mov_b32 v39, 12416
v_mov_b32 v40, 12416
v_mov_b32 v41, 12416
s_add_u32 s32, s48, 10485760
s_addc_u32 s33, s49, 0
s_mov_b32 s34, 1835008
s_mov_b32 s35, 0x20000
s_add_u32 s56, s48, 8388608
s_addc_u32 s57, s49, 0
s_mov_b32 s58, 1835008
s_mov_b32 s59, 0x20000
v_mov_b32 v5, 0
v_lshrrev_b32 v6, 7, v0
v_mul_u32_u24 v6, 4608, v6
v_and_b32 v7, 127, v0
v_lshl_add_u32 v6, v7, 2, v6
v_add_u32 v6, 72608, v6
ds_write_b32 v6, v5

s_waitcnt vmcnt(6)
v_lshlrev_b32 v8, 16, v8
v_lshlrev_b32 v9, 16, v9
v_lshlrev_b32 v10, 16, v10
v_lshlrev_b32 v11, 16, v11
v_lshlrev_b32 v12, 16, v12
v_lshlrev_b32 v13, 16, v13
v_mul_f32 v58, 1069066811, v12
v_mul_f32 v88, 1069066811, v8
v_fma_f32 v59, v12, s60, -v58
v_fma_f32 v89, v8, s60, -v88
v_fmac_f32 v59, 849703008, v12
v_fmac_f32 v89, 849703008, v8
v_exp_f32 v58, v58
v_exp_f32 v88, v88
v_mul_f32 v59, 1060205080, v59
v_mul_f32 v89, 1060205080, v89
v_fmac_f32 v58, v58, v59
v_fmac_f32 v88, v88, v89
v_cvt_pk_bf16_f32 v58, v58, v58
v_cvt_pk_bf16_f32 v88, v88, v88
v_and_b32 v44, 0xffff0000, v58
v_and_b32 v42, 0xffff0000, v88
v_mul_f32 v42, v42, v44
v_mul_f32 v43, v9, v44
s_mul_i32 s50, s24, 13992
v_lshlrev_b32 v45, 2, v2
v_mul_f32 v42, 3216550459, v42
v_mul_f32 v43, 0.15915494, v43
v_add_f32 v44, v44, v44
v_add_u32 v45, s50, v45
v_mov_b32 v64, v10
v_sub_f32 v65, 0, v11

v_mul_f32 v104, 1065353216, v42
v_mul_f32 v107, 1090519040, v42
v_mul_f32 v110, 1098907648, v42
v_mul_f32 v113, 1132462080, v42
v_mul_f32 v105, 1065353216, v43
v_mul_f32 v108, 1090519040, v43
v_mul_f32 v111, 1098907648, v43
v_mul_f32 v114, 1132462080, v43
v_exp_f32 v104, v104
v_exp_f32 v107, v107
v_exp_f32 v110, v110
v_exp_f32 v113, v113
v_fract_f32 v105, v105
v_fract_f32 v108, v108
v_fract_f32 v111, v111
v_fract_f32 v114, v114
v_cos_f32 v106, v105
v_cos_f32 v109, v108
v_cos_f32 v112, v111
v_cos_f32 v115, v114
v_sin_f32 v105, v105
v_sin_f32 v108, v108
v_sin_f32 v111, v111
v_sin_f32 v114, v114
v_mul_f32 v46, v104, v106
v_mul_f32 v50, v107, v109
v_mul_f32 v96, v110, v112
v_mul_f32 v54, v113, v115
v_mul_f32 v47, v104, v105
v_mul_f32 v51, v107, v108
v_mul_f32 v97, v110, v111
v_mul_f32 v55, v113, v114
v_sub_f32 v48, 0, v47
v_sub_f32 v52, 0, v51
v_sub_f32 v98, 0, v97
v_sub_f32 v56, 0, v55
v_cvt_pk_bf16_f32 v76, v64, v65
v_mov_b32 v88, 1.0
ds_write_b32 v45, v76 offset:0
v_cvt_pk_bf16_f32 v102, v50, v51
v_mul_f32 v72, v64, v46
v_mov_b32 v89, 0
v_mul_f32 v73, v64, v48
ds_write_b32 v45, v102 offset:5808
v_fmac_f32 v72, v65, v47
v_cvt_pk_bf16_f32 v100, v88, v89
v_fmac_f32 v73, v65, v46
v_mul_f32 v92, v50, v96
v_cvt_pk_bf16_f32 v77, v72, v73
ds_write_b32 v45, v100 offset:5544
ds_write_b32 v45, v77 offset:264
v_mul_f32 v93, v50, v97
v_mul_f32 v66, v72, v46
v_cvt_pk_bf16_f32 v101, v96, v97
v_mul_f32 v67, v72, v48
v_fmac_f32 v92, v51, v98
v_fmac_f32 v66, v73, v47
ds_write_b32 v45, v101 offset:6072
v_fmac_f32 v67, v73, v46
v_fmac_f32 v93, v51, v96
v_cvt_pk_bf16_f32 v78, v66, v67
v_mul_f32 v88, v96, v96
ds_write_b32 v45, v78 offset:528
v_cvt_pk_bf16_f32 v103, v92, v93
v_mul_f32 v72, v66, v46
v_mul_f32 v89, v96, v97
v_mul_f32 v73, v66, v48
ds_write_b32 v45, v103 offset:6336
v_fmac_f32 v72, v67, v47
v_fmac_f32 v88, v97, v98
v_fmac_f32 v73, v67, v46
v_mul_f32 v94, v92, v96
v_cvt_pk_bf16_f32 v79, v72, v73
v_fmac_f32 v89, v97, v96
ds_write_b32 v45, v79 offset:792
v_mul_f32 v95, v92, v97
v_mul_f32 v68, v72, v46
v_cvt_pk_bf16_f32 v100, v88, v89
v_mul_f32 v69, v72, v48
v_fmac_f32 v94, v93, v98
v_fmac_f32 v68, v73, v47
ds_write_b32 v45, v100 offset:6600
v_fmac_f32 v69, v73, v46
v_fmac_f32 v95, v93, v96
v_cvt_pk_bf16_f32 v76, v68, v69
v_mul_f32 v90, v88, v96
ds_write_b32 v45, v76 offset:1056
v_cvt_pk_bf16_f32 v102, v94, v95
v_mul_f32 v72, v68, v46
v_mul_f32 v91, v88, v97
v_mul_f32 v73, v68, v48
ds_write_b32 v45, v102 offset:6864
v_fmac_f32 v72, v69, v47
v_fmac_f32 v90, v89, v98
v_fmac_f32 v73, v69, v46
v_mul_f32 v92, v94, v96
v_cvt_pk_bf16_f32 v77, v72, v73
v_fmac_f32 v91, v89, v96
ds_write_b32 v45, v77 offset:1320
v_mul_f32 v93, v94, v97
v_mul_f32 v70, v72, v46
v_cvt_pk_bf16_f32 v101, v90, v91
v_mul_f32 v71, v72, v48
v_fmac_f32 v92, v95, v98
v_fmac_f32 v70, v73, v47
ds_write_b32 v45, v101 offset:7128
v_fmac_f32 v71, v73, v46
v_fmac_f32 v93, v95, v96
v_cvt_pk_bf16_f32 v78, v70, v71
v_mul_f32 v88, v90, v96
ds_write_b32 v45, v78 offset:1584
v_cvt_pk_bf16_f32 v103, v92, v93
v_mul_f32 v72, v70, v46
v_mul_f32 v89, v90, v97
v_mul_f32 v73, v70, v48
ds_write_b32 v45, v103 offset:7392
v_fmac_f32 v72, v71, v47
v_fmac_f32 v88, v91, v98
v_fmac_f32 v73, v71, v46
v_mul_f32 v94, v92, v96
v_cvt_pk_bf16_f32 v79, v72, v73
v_fmac_f32 v89, v91, v96
ds_write_b32 v45, v79 offset:1848
v_mul_f32 v95, v92, v97
v_mul_f32 v80, v64, v54
v_cvt_pk_bf16_f32 v100, v88, v89
v_mul_f32 v81, v64, v56
v_fmac_f32 v94, v93, v98
v_fmac_f32 v80, v65, v55
ds_write_b32 v45, v100 offset:7656
v_fmac_f32 v81, v65, v54
v_fmac_f32 v95, v93, v96
v_cvt_pk_bf16_f32 v76, v80, v81
v_mul_f32 v90, v88, v96
ds_write_b32 v45, v76 offset:2112
v_cvt_pk_bf16_f32 v102, v94, v95
v_mul_f32 v84, v66, v54
v_mul_f32 v91, v88, v97
v_mul_f32 v85, v66, v56
ds_write_b32 v45, v102 offset:7920
v_fmac_f32 v84, v67, v55
v_fmac_f32 v90, v89, v98
v_fmac_f32 v85, v67, v54
v_mul_f32 v92, v94, v96
v_cvt_pk_bf16_f32 v77, v84, v85
v_fmac_f32 v91, v89, v96
ds_write_b32 v45, v77 offset:2376
v_mul_f32 v93, v94, v97
v_mul_f32 v82, v68, v54
v_cvt_pk_bf16_f32 v101, v90, v91
v_mul_f32 v83, v68, v56
v_fmac_f32 v92, v95, v98
v_fmac_f32 v82, v69, v55
ds_write_b32 v45, v101 offset:8184
v_fmac_f32 v83, v69, v54
v_fmac_f32 v93, v95, v96
v_cvt_pk_bf16_f32 v78, v82, v83
v_mul_f32 v88, v90, v96
ds_write_b32 v45, v78 offset:2640
v_cvt_pk_bf16_f32 v103, v92, v93
v_mul_f32 v84, v70, v54
v_mul_f32 v89, v90, v97
v_mul_f32 v85, v70, v56
ds_write_b32 v45, v103 offset:8448
v_fmac_f32 v84, v71, v55
v_fmac_f32 v88, v91, v98
v_fmac_f32 v85, v71, v54
v_mul_f32 v94, v92, v96
v_cvt_pk_bf16_f32 v79, v84, v85
v_fmac_f32 v89, v91, v96
ds_write_b32 v45, v79 offset:2904
v_mul_f32 v95, v92, v97
v_mul_f32 v84, v80, v54
v_cvt_pk_bf16_f32 v100, v88, v89
v_mul_f32 v85, v80, v56
v_fmac_f32 v94, v93, v98
v_fmac_f32 v84, v81, v55
ds_write_b32 v45, v100 offset:8712
v_fmac_f32 v85, v81, v54
v_fmac_f32 v95, v93, v96
v_cvt_pk_bf16_f32 v76, v84, v85
v_mul_f32 v90, v88, v96
ds_write_b32 v45, v76 offset:3168
v_cvt_pk_bf16_f32 v102, v94, v95
v_mul_f32 v86, v82, v54
v_mul_f32 v91, v88, v97
v_mul_f32 v87, v82, v56
ds_write_b32 v45, v102 offset:8976
v_fmac_f32 v86, v83, v55
v_fmac_f32 v90, v89, v98
v_fmac_f32 v87, v83, v54
v_mul_f32 v92, v94, v96
v_cvt_pk_bf16_f32 v77, v86, v87
v_fmac_f32 v91, v89, v96
ds_write_b32 v45, v77 offset:3432
v_mul_f32 v93, v94, v97
v_mul_f32 v80, v84, v54
v_cvt_pk_bf16_f32 v101, v90, v91
v_mul_f32 v81, v84, v56
v_fmac_f32 v92, v95, v98
v_fmac_f32 v80, v85, v55
ds_write_b32 v45, v101 offset:9240
v_fmac_f32 v81, v85, v54
v_fmac_f32 v93, v95, v96
v_cvt_pk_bf16_f32 v78, v80, v81
v_mul_f32 v88, v90, v96
ds_write_b32 v45, v78 offset:3696
v_cvt_pk_bf16_f32 v103, v92, v93
v_mul_f32 v82, v86, v54
v_mul_f32 v89, v90, v97
v_mul_f32 v83, v86, v56
ds_write_b32 v45, v103 offset:9504
v_fmac_f32 v82, v87, v55
v_fmac_f32 v88, v91, v98
v_fmac_f32 v83, v87, v54
v_mul_f32 v94, v92, v96
v_cvt_pk_bf16_f32 v79, v82, v83
v_fmac_f32 v89, v91, v96
ds_write_b32 v45, v79 offset:3960
v_mul_f32 v95, v92, v97
v_mul_f32 v84, v80, v54
v_cvt_pk_bf16_f32 v100, v88, v89
v_mul_f32 v85, v80, v56
v_fmac_f32 v94, v93, v98
v_fmac_f32 v84, v81, v55
ds_write_b32 v45, v100 offset:9768
v_fmac_f32 v85, v81, v54
v_fmac_f32 v95, v93, v96
v_cvt_pk_bf16_f32 v76, v84, v85
v_mul_f32 v90, v88, v96
ds_write_b32 v45, v76 offset:4224
v_cvt_pk_bf16_f32 v102, v94, v95
v_mul_f32 v80, v84, v54
v_mul_f32 v91, v88, v97
v_mul_f32 v81, v84, v56
ds_write_b32 v45, v102 offset:10032
v_fmac_f32 v80, v85, v55
v_fmac_f32 v90, v89, v98
v_fmac_f32 v81, v85, v54
v_mul_f32 v92, v94, v96
v_cvt_pk_bf16_f32 v77, v80, v81
v_fmac_f32 v91, v89, v96
ds_write_b32 v45, v77 offset:4488
v_mul_f32 v93, v94, v97
v_mul_f32 v84, v80, v54
v_cvt_pk_bf16_f32 v101, v90, v91
v_mul_f32 v85, v80, v56
v_fmac_f32 v92, v95, v98
v_fmac_f32 v84, v81, v55
ds_write_b32 v45, v101 offset:10296
v_fmac_f32 v85, v81, v54
v_fmac_f32 v93, v95, v96
v_cvt_pk_bf16_f32 v78, v84, v85
v_mul_f32 v88, v90, v96
ds_write_b32 v45, v78 offset:4752
v_cvt_pk_bf16_f32 v103, v92, v93
v_mul_f32 v80, v84, v54
v_mul_f32 v89, v90, v97
v_mul_f32 v81, v84, v56
ds_write_b32 v45, v103 offset:10560
v_fmac_f32 v80, v85, v55
v_fmac_f32 v88, v91, v98
v_fmac_f32 v81, v85, v54
v_mul_f32 v94, v92, v96
v_cvt_pk_bf16_f32 v79, v80, v81
v_fmac_f32 v89, v91, v96
ds_write_b32 v45, v79 offset:5016
v_mul_f32 v95, v92, v97
v_mul_f32 v84, v80, v54
v_cvt_pk_bf16_f32 v100, v88, v89
v_mul_f32 v85, v80, v56
v_fmac_f32 v94, v93, v98
v_fmac_f32 v84, v81, v55
ds_write_b32 v45, v100 offset:10824
v_fmac_f32 v85, v81, v54
v_fmac_f32 v95, v93, v96
v_cvt_pk_bf16_f32 v76, v84, v85
v_mul_f32 v90, v88, v96
ds_write_b32 v45, v76 offset:5280
v_cvt_pk_bf16_f32 v102, v94, v95
v_mul_f32 v91, v88, v97
ds_write_b32 v45, v102 offset:11088
v_fmac_f32 v90, v89, v98
v_mul_f32 v92, v94, v96
v_fmac_f32 v91, v89, v96
v_mul_f32 v93, v94, v97
v_cvt_pk_bf16_f32 v101, v90, v91
v_fmac_f32 v92, v95, v98
ds_write_b32 v45, v101 offset:11352
v_fmac_f32 v93, v95, v96
v_mul_f32 v88, v90, v96
v_cvt_pk_bf16_f32 v103, v92, v93
v_mul_f32 v89, v90, v97
ds_write_b32 v45, v103 offset:11616
v_fmac_f32 v88, v91, v98
v_mul_f32 v94, v92, v96
v_fmac_f32 v89, v91, v96
v_mul_f32 v95, v92, v97
v_cvt_pk_bf16_f32 v100, v88, v89
v_fmac_f32 v94, v93, v98
ds_write_b32 v45, v100 offset:11880
v_fmac_f32 v95, v93, v96
v_mul_f32 v90, v88, v96
v_cvt_pk_bf16_f32 v102, v94, v95
v_mul_f32 v91, v88, v97
ds_write_b32 v45, v102 offset:12144
v_fmac_f32 v90, v89, v98
v_mul_f32 v92, v94, v96
v_fmac_f32 v91, v89, v96
v_mul_f32 v93, v94, v97
v_cvt_pk_bf16_f32 v101, v90, v91
v_fmac_f32 v92, v95, v98
ds_write_b32 v45, v101 offset:12408
v_fmac_f32 v93, v95, v96
v_mul_f32 v88, v90, v96
v_cvt_pk_bf16_f32 v103, v92, v93
v_mul_f32 v89, v90, v97
ds_write_b32 v45, v103 offset:12672
v_fmac_f32 v88, v91, v98
v_mul_f32 v94, v92, v96
v_fmac_f32 v89, v91, v96
v_mul_f32 v95, v92, v97
v_cvt_pk_bf16_f32 v100, v88, v89
v_fmac_f32 v94, v93, v98
ds_write_b32 v45, v100 offset:12936
v_fmac_f32 v95, v93, v96
v_mul_f32 v90, v88, v96
v_cvt_pk_bf16_f32 v102, v94, v95
v_mul_f32 v91, v88, v97
ds_write_b32 v45, v102 offset:13200
v_fmac_f32 v90, v89, v98
v_mul_f32 v92, v94, v96
v_fmac_f32 v91, v89, v96
v_mul_f32 v93, v94, v97
v_cvt_pk_bf16_f32 v101, v90, v91
v_fmac_f32 v92, v95, v98
ds_write_b32 v45, v101 offset:13464
v_fmac_f32 v93, v95, v96
v_cvt_pk_bf16_f32 v103, v92, v93
ds_write_b32 v45, v103 offset:13728
v_and_b32 v58, 31, v2
v_lshrrev_b32 v59, 5, v2
v_lshlrev_b32 v59, 4, v59
v_add_u32 v59, s50, v59
v_min_u32 v60, 20, v58
v_mul_u32_u24 v60, 264, v60
v_add_u32 v60, v60, v59
v_mul_u32_u24 v58, 264, v58
v_add_u32 v58, v58, v59

v_mov_b32 v88, 0
v_mov_b32 v89, 0
v_mov_b32 v90, 0
v_mov_b32 v91, 0
v_mov_b32 v92, 0
v_mov_b32 v93, 0
v_mov_b32 v94, 0
v_mov_b32 v95, 0
v_mov_b32 v96, 0
v_mov_b32 v97, 0
v_mov_b32 v98, 0
v_mov_b32 v99, 0
v_mov_b32 v100, 0
v_mov_b32 v101, 0
v_mov_b32 v102, 0
v_mov_b32 v103, 0
s_waitcnt lgkmcnt(0)
v_add_u32 v58, 5544, v58
ds_read2_b64 v[104:107], v60 offset0:0 offset1:1
ds_read2_b64 v[108:111], v58 offset0:0 offset1:1
ds_read2_b64 v[112:115], v60 offset0:4 offset1:5
ds_read2_b64 v[116:119], v58 offset0:4 offset1:5
ds_read2_b64 v[120:123], v60 offset0:8 offset1:9
ds_read2_b64 v[124:127], v58 offset0:8 offset1:9
s_waitcnt lgkmcnt(4)
v_mfma_f32_32x32x16_bf16 v[88:103], v[104:107], v[108:111], v[88:103]
ds_read2_b64 v[104:107], v60 offset0:12 offset1:13
ds_read2_b64 v[108:111], v58 offset0:12 offset1:13
s_waitcnt lgkmcnt(4)
v_mfma_f32_32x32x16_bf16 v[88:103], v[112:115], v[116:119], v[88:103]
ds_read2_b64 v[112:115], v60 offset0:16 offset1:17
ds_read2_b64 v[116:119], v58 offset0:16 offset1:17
s_waitcnt lgkmcnt(4)
v_mfma_f32_32x32x16_bf16 v[88:103], v[120:123], v[124:127], v[88:103]
ds_read2_b64 v[120:123], v60 offset0:20 offset1:21
ds_read2_b64 v[124:127], v58 offset0:20 offset1:21
s_waitcnt lgkmcnt(4)
v_mfma_f32_32x32x16_bf16 v[88:103], v[104:107], v[108:111], v[88:103]
ds_read2_b64 v[104:107], v60 offset0:24 offset1:25
ds_read2_b64 v[108:111], v58 offset0:24 offset1:25
s_waitcnt lgkmcnt(4)
v_mfma_f32_32x32x16_bf16 v[88:103], v[112:115], v[116:119], v[88:103]
ds_read2_b64 v[112:115], v60 offset0:28 offset1:29
ds_read2_b64 v[116:119], v58 offset0:28 offset1:29
s_waitcnt lgkmcnt(4)
v_mfma_f32_32x32x16_bf16 v[88:103], v[120:123], v[124:127], v[88:103]
s_waitcnt lgkmcnt(2)
v_mfma_f32_32x32x16_bf16 v[88:103], v[104:107], v[108:111], v[88:103]
s_waitcnt lgkmcnt(0)
v_mfma_f32_32x32x16_bf16 v[88:103], v[112:115], v[116:119], v[88:103]
v_and_b32 v58, 31, v2
v_lshlrev_b32 v58, 2, v58
v_lshrrev_b32 v59, 5, v2
v_lshl_add_u32 v58, v59, 9, v58
v_add_u32 v58, s50, v58
s_nop 15

ds_write_b32 v58, v88 offset:0
ds_write_b32 v58, v89 offset:128
ds_write_b32 v58, v90 offset:256
ds_write_b32 v58, v91 offset:384
ds_write_b32 v58, v92 offset:1024
ds_write_b32 v58, v93 offset:1152
ds_write_b32 v58, v94 offset:1280
ds_write_b32 v58, v95 offset:1408
ds_write_b32 v58, v96 offset:2048
ds_write_b32 v58, v97 offset:2176
ds_write_b32 v58, v98 offset:2304
ds_write_b32 v58, v99 offset:2432
s_waitcnt lgkmcnt(0)
s_barrier
v_lshlrev_b32 v58, 2, v0

ds_read_b32 v88, v58 offset:0
ds_read_b32 v89, v58 offset:13992
ds_read_b32 v90, v58 offset:27984
ds_read_b32 v91, v58 offset:41976
ds_read_b32 v92, v58 offset:1024
ds_read_b32 v93, v58 offset:15016
ds_read_b32 v94, v58 offset:29008
ds_read_b32 v95, v58 offset:43000
ds_read_b32 v96, v58 offset:2048
ds_read_b32 v97, v58 offset:16040
ds_read_b32 v98, v58 offset:30032
ds_read_b32 v99, v58 offset:44024
v_lshrrev_b32 v59, 5, v0
v_and_b32 v60, 31, v0
v_lshlrev_b32 v60, 2, v60
v_lshlrev_b32 v61, 8, v59
v_add_u32 v61, 1024, v61
v_lshlrev_b32 v62, 9, v59
v_cmp_gt_u32 vcc, 4, v59
s_nop 1
v_cndmask_b32 v61, v62, v61, vcc
v_add_u32 v61, v61, v60
v_lshlrev_b32 v62, 10, v59
v_add_u32 v62, v62, v60
s_waitcnt lgkmcnt(0)

v_add_f32 v88, v88, v89
v_add_f32 v90, v90, v91
v_add_f32 v88, v88, v90
v_mul_f32 v88, v88, v44

v_add_f32 v92, v92, v93
v_add_f32 v94, v94, v95
v_add_f32 v92, v92, v94
v_mul_f32 v92, v92, v44

v_add_f32 v96, v96, v97
v_add_f32 v98, v98, v99
v_add_f32 v96, v96, v98
v_mul_f32 v96, v96, v44

ds_write_b32 v58, v88 offset:4096
ds_write_b32 v61, v92 offset:4096
v_cmp_gt_u32 vcc, 5, v59
s_and_saveexec_b64 s[52:53], vcc
ds_write_b32 v62, v96 offset:8192
s_mov_b64 exec, s[52:53]
v_mov_b32 v61, 0
v_mov_b32 v62, 12416
ds_write_b32 v62, v61
s_waitcnt lgkmcnt(0)
s_barrier

ds_read_b32 v88, v24
ds_read_b32 v89, v25
ds_read_b32 v90, v26
ds_read_b32 v91, v27
ds_read_b32 v92, v28
ds_read_b32 v93, v29
ds_read_b32 v94, v30
ds_read_b32 v95, v31
ds_read_b32 v96, v32
v_lshlrev_b32 v58, 4, v0
v_add_u32 v58, 55968, v58
s_waitcnt lgkmcnt(0)
v_cvt_pk_bf16_f32 v104, v89, v90
v_cvt_pk_bf16_f32 v108, v88, v89
v_cvt_pk_bf16_f32 v105, v91, v92
v_cvt_pk_bf16_f32 v109, v90, v91
v_cvt_pk_bf16_f32 v106, v93, v94
v_cvt_pk_bf16_f32 v110, v92, v93
v_cvt_pk_bf16_f32 v107, v95, v96
v_cvt_pk_bf16_f32 v111, v94, v95
ds_write_b128 v58, v[104:107] offset:0
ds_write_b128 v58, v[108:111] offset:4160
v_cmp_gt_u32 vcc, 4, v0
s_and_saveexec_b64 s[52:53], vcc
s_cbranch_execz L_exp_20
ds_read_b32 v88, v33
ds_read_b32 v89, v34
ds_read_b32 v90, v35
ds_read_b32 v91, v36
ds_read_b32 v92, v37
ds_read_b32 v93, v38
ds_read_b32 v94, v39
ds_read_b32 v95, v40
ds_read_b32 v96, v41
v_lshlrev_b32 v58, 4, v0
v_add_u32 v58, 55968, v58
s_waitcnt lgkmcnt(0)
v_cvt_pk_bf16_f32 v104, v89, v90
v_cvt_pk_bf16_f32 v108, v88, v89
v_cvt_pk_bf16_f32 v105, v91, v92
v_cvt_pk_bf16_f32 v109, v90, v91
v_cvt_pk_bf16_f32 v106, v93, v94
v_cvt_pk_bf16_f32 v110, v92, v93
v_cvt_pk_bf16_f32 v107, v95, v96
v_cvt_pk_bf16_f32 v111, v94, v95
ds_write_b128 v58, v[104:107] offset:4096
ds_write_b128 v58, v[108:111] offset:8256
L_exp_20:
s_mov_b64 exec, s[52:53]
s_waitcnt lgkmcnt(0)
s_barrier
s_setprio 0
s_load_dwordx2 s[62:63], s[0:1], 104
s_waitcnt lgkmcnt(0)
s_add_u32 s44, s62, 16777216
s_addc_u32 s45, s63, 0
s_mov_b32 s46, 65536
s_mov_b32 s47, 0x20000
s_load_dwordx2 s[62:63], s[0:1], 96
s_waitcnt vmcnt(0) lgkmcnt(0)
v_mov_b32 v201, 0
global_load_dword v200, v201, s[62:63] sc1
v_lshlrev_b32 v16, 16, v16
v_lshlrev_b32 v17, 16, v17
v_lshlrev_b32 v18, 16, v18
v_lshlrev_b32 v19, 16, v19
v_lshlrev_b32 v20, 16, v20
v_lshlrev_b32 v21, 16, v21
v_mul_f32 v58, 1069066811, v20
v_mul_f32 v88, 1069066811, v16
v_fma_f32 v59, v20, s60, -v58
v_fma_f32 v89, v16, s60, -v88
v_fmac_f32 v59, 849703008, v20
v_fmac_f32 v89, 849703008, v16
v_exp_f32 v58, v58
v_exp_f32 v88, v88
v_mul_f32 v59, 1060205080, v59
v_mul_f32 v89, 1060205080, v89
v_fmac_f32 v58, v58, v59
v_fmac_f32 v88, v88, v89
v_cvt_pk_bf16_f32 v58, v58, v58
v_cvt_pk_bf16_f32 v88, v88, v88
v_and_b32 v44, 0xffff0000, v58
v_and_b32 v42, 0xffff0000, v88
v_mul_f32 v42, v42, v44
v_mul_f32 v43, v17, v44
s_mul_i32 s50, s24, 13992
v_lshlrev_b32 v45, 2, v2
v_mul_f32 v42, 3216550459, v42
v_mul_f32 v43, 0.15915494, v43
v_add_f32 v44, v44, v44
v_add_u32 v45, s50, v45
v_mov_b32 v64, v18
v_sub_f32 v65, 0, v19

v_mul_f32 v104, 1065353216, v42
v_mul_f32 v107, 1090519040, v42
v_mul_f32 v110, 1098907648, v42
v_mul_f32 v113, 1132462080, v42
v_mul_f32 v105, 1065353216, v43
v_mul_f32 v108, 1090519040, v43
v_mul_f32 v111, 1098907648, v43
v_mul_f32 v114, 1132462080, v43
v_exp_f32 v104, v104
v_exp_f32 v107, v107
v_exp_f32 v110, v110
v_exp_f32 v113, v113
v_fract_f32 v105, v105
v_fract_f32 v108, v108
v_fract_f32 v111, v111
v_fract_f32 v114, v114
v_cos_f32 v106, v105
v_cos_f32 v109, v108
v_cos_f32 v112, v111
v_cos_f32 v115, v114
v_sin_f32 v105, v105
v_sin_f32 v108, v108
v_sin_f32 v111, v111
v_sin_f32 v114, v114
v_mul_f32 v46, v104, v106
v_mul_f32 v50, v107, v109
v_mul_f32 v96, v110, v112
v_mul_f32 v54, v113, v115
v_mul_f32 v47, v104, v105
v_mul_f32 v51, v107, v108
v_mul_f32 v97, v110, v111
v_mul_f32 v55, v113, v114
v_sub_f32 v48, 0, v47
v_sub_f32 v52, 0, v51
v_sub_f32 v98, 0, v97
v_sub_f32 v56, 0, v55
v_cvt_pk_bf16_f32 v76, v64, v65
v_mov_b32 v88, 1.0
ds_write_b32 v45, v76 offset:0
v_cvt_pk_bf16_f32 v102, v50, v51
v_mul_f32 v72, v64, v46
v_mov_b32 v89, 0
v_mul_f32 v73, v64, v48
ds_write_b32 v45, v102 offset:5808
v_fmac_f32 v72, v65, v47
v_cvt_pk_bf16_f32 v100, v88, v89
v_fmac_f32 v73, v65, v46
v_mul_f32 v92, v50, v96
v_cvt_pk_bf16_f32 v77, v72, v73
ds_write_b32 v45, v100 offset:5544
ds_write_b32 v45, v77 offset:264
v_mul_f32 v93, v50, v97
v_mul_f32 v66, v72, v46
v_cvt_pk_bf16_f32 v101, v96, v97
v_mul_f32 v67, v72, v48
v_fmac_f32 v92, v51, v98
v_fmac_f32 v66, v73, v47
ds_write_b32 v45, v101 offset:6072
v_fmac_f32 v67, v73, v46
v_fmac_f32 v93, v51, v96
v_cvt_pk_bf16_f32 v78, v66, v67
v_mul_f32 v88, v96, v96
ds_write_b32 v45, v78 offset:528
v_cvt_pk_bf16_f32 v103, v92, v93
v_mul_f32 v72, v66, v46
v_mul_f32 v89, v96, v97
v_mul_f32 v73, v66, v48
ds_write_b32 v45, v103 offset:6336
v_fmac_f32 v72, v67, v47
v_fmac_f32 v88, v97, v98
v_fmac_f32 v73, v67, v46
v_mul_f32 v94, v92, v96
v_cvt_pk_bf16_f32 v79, v72, v73
v_fmac_f32 v89, v97, v96
ds_write_b32 v45, v79 offset:792
v_mul_f32 v95, v92, v97
v_mul_f32 v68, v72, v46
v_cvt_pk_bf16_f32 v100, v88, v89
v_mul_f32 v69, v72, v48
v_fmac_f32 v94, v93, v98
v_fmac_f32 v68, v73, v47
ds_write_b32 v45, v100 offset:6600
v_fmac_f32 v69, v73, v46
v_fmac_f32 v95, v93, v96
v_cvt_pk_bf16_f32 v76, v68, v69
v_mul_f32 v90, v88, v96
ds_write_b32 v45, v76 offset:1056
v_cvt_pk_bf16_f32 v102, v94, v95
v_mul_f32 v72, v68, v46
v_mul_f32 v91, v88, v97
v_mul_f32 v73, v68, v48
ds_write_b32 v45, v102 offset:6864
v_fmac_f32 v72, v69, v47
v_fmac_f32 v90, v89, v98
v_fmac_f32 v73, v69, v46
v_mul_f32 v92, v94, v96
v_cvt_pk_bf16_f32 v77, v72, v73
v_fmac_f32 v91, v89, v96
ds_write_b32 v45, v77 offset:1320
v_mul_f32 v93, v94, v97
v_mul_f32 v70, v72, v46
v_cvt_pk_bf16_f32 v101, v90, v91
v_mul_f32 v71, v72, v48
v_fmac_f32 v92, v95, v98
v_fmac_f32 v70, v73, v47
ds_write_b32 v45, v101 offset:7128
v_fmac_f32 v71, v73, v46
v_fmac_f32 v93, v95, v96
v_cvt_pk_bf16_f32 v78, v70, v71
v_mul_f32 v88, v90, v96
ds_write_b32 v45, v78 offset:1584
v_cvt_pk_bf16_f32 v103, v92, v93
v_mul_f32 v72, v70, v46
v_mul_f32 v89, v90, v97
v_mul_f32 v73, v70, v48
ds_write_b32 v45, v103 offset:7392
v_fmac_f32 v72, v71, v47
v_fmac_f32 v88, v91, v98
v_fmac_f32 v73, v71, v46
v_mul_f32 v94, v92, v96
v_cvt_pk_bf16_f32 v79, v72, v73
v_fmac_f32 v89, v91, v96
ds_write_b32 v45, v79 offset:1848
v_mul_f32 v95, v92, v97
v_mul_f32 v80, v64, v54
v_cvt_pk_bf16_f32 v100, v88, v89
v_mul_f32 v81, v64, v56
v_fmac_f32 v94, v93, v98
v_fmac_f32 v80, v65, v55
ds_write_b32 v45, v100 offset:7656
v_fmac_f32 v81, v65, v54
v_fmac_f32 v95, v93, v96
v_cvt_pk_bf16_f32 v76, v80, v81
v_mul_f32 v90, v88, v96
ds_write_b32 v45, v76 offset:2112
v_cvt_pk_bf16_f32 v102, v94, v95
v_mul_f32 v84, v66, v54
v_mul_f32 v91, v88, v97
v_mul_f32 v85, v66, v56
ds_write_b32 v45, v102 offset:7920
v_fmac_f32 v84, v67, v55
v_fmac_f32 v90, v89, v98
v_fmac_f32 v85, v67, v54
v_mul_f32 v92, v94, v96
v_cvt_pk_bf16_f32 v77, v84, v85
v_fmac_f32 v91, v89, v96
ds_write_b32 v45, v77 offset:2376
v_mul_f32 v93, v94, v97
v_mul_f32 v82, v68, v54
v_cvt_pk_bf16_f32 v101, v90, v91
v_mul_f32 v83, v68, v56
v_fmac_f32 v92, v95, v98
v_fmac_f32 v82, v69, v55
ds_write_b32 v45, v101 offset:8184
v_fmac_f32 v83, v69, v54
v_fmac_f32 v93, v95, v96
v_cvt_pk_bf16_f32 v78, v82, v83
v_mul_f32 v88, v90, v96
ds_write_b32 v45, v78 offset:2640
v_cvt_pk_bf16_f32 v103, v92, v93
v_mul_f32 v84, v70, v54
v_mul_f32 v89, v90, v97
v_mul_f32 v85, v70, v56
ds_write_b32 v45, v103 offset:8448
v_fmac_f32 v84, v71, v55
v_fmac_f32 v88, v91, v98
v_fmac_f32 v85, v71, v54
v_mul_f32 v94, v92, v96
v_cvt_pk_bf16_f32 v79, v84, v85
v_fmac_f32 v89, v91, v96
ds_write_b32 v45, v79 offset:2904
v_mul_f32 v95, v92, v97
v_mul_f32 v84, v80, v54
v_cvt_pk_bf16_f32 v100, v88, v89
v_mul_f32 v85, v80, v56
v_fmac_f32 v94, v93, v98
v_fmac_f32 v84, v81, v55
ds_write_b32 v45, v100 offset:8712
v_fmac_f32 v85, v81, v54
v_fmac_f32 v95, v93, v96
v_cvt_pk_bf16_f32 v76, v84, v85
v_mul_f32 v90, v88, v96
ds_write_b32 v45, v76 offset:3168
v_cvt_pk_bf16_f32 v102, v94, v95
v_mul_f32 v86, v82, v54
v_mul_f32 v91, v88, v97
v_mul_f32 v87, v82, v56
ds_write_b32 v45, v102 offset:8976
v_fmac_f32 v86, v83, v55
v_fmac_f32 v90, v89, v98
v_fmac_f32 v87, v83, v54
v_mul_f32 v92, v94, v96
v_cvt_pk_bf16_f32 v77, v86, v87
v_fmac_f32 v91, v89, v96
ds_write_b32 v45, v77 offset:3432
v_mul_f32 v93, v94, v97
v_mul_f32 v80, v84, v54
v_cvt_pk_bf16_f32 v101, v90, v91
v_mul_f32 v81, v84, v56
v_fmac_f32 v92, v95, v98
v_fmac_f32 v80, v85, v55
ds_write_b32 v45, v101 offset:9240
v_fmac_f32 v81, v85, v54
v_fmac_f32 v93, v95, v96
v_cvt_pk_bf16_f32 v78, v80, v81
v_mul_f32 v88, v90, v96
ds_write_b32 v45, v78 offset:3696
v_cvt_pk_bf16_f32 v103, v92, v93
v_mul_f32 v82, v86, v54
v_mul_f32 v89, v90, v97
v_mul_f32 v83, v86, v56
ds_write_b32 v45, v103 offset:9504
v_fmac_f32 v82, v87, v55
v_fmac_f32 v88, v91, v98
v_fmac_f32 v83, v87, v54
v_mul_f32 v94, v92, v96
v_cvt_pk_bf16_f32 v79, v82, v83
v_fmac_f32 v89, v91, v96
ds_write_b32 v45, v79 offset:3960
v_mul_f32 v95, v92, v97
v_mul_f32 v84, v80, v54
v_cvt_pk_bf16_f32 v100, v88, v89
v_mul_f32 v85, v80, v56
v_fmac_f32 v94, v93, v98
v_fmac_f32 v84, v81, v55
ds_write_b32 v45, v100 offset:9768
v_fmac_f32 v85, v81, v54
v_fmac_f32 v95, v93, v96
v_cvt_pk_bf16_f32 v76, v84, v85
v_mul_f32 v90, v88, v96
ds_write_b32 v45, v76 offset:4224
v_cvt_pk_bf16_f32 v102, v94, v95
v_mul_f32 v80, v84, v54
v_mul_f32 v91, v88, v97
v_mul_f32 v81, v84, v56
ds_write_b32 v45, v102 offset:10032
v_fmac_f32 v80, v85, v55
v_fmac_f32 v90, v89, v98
v_fmac_f32 v81, v85, v54
v_mul_f32 v92, v94, v96
v_cvt_pk_bf16_f32 v77, v80, v81
v_fmac_f32 v91, v89, v96
ds_write_b32 v45, v77 offset:4488
v_mul_f32 v93, v94, v97
v_mul_f32 v84, v80, v54
v_cvt_pk_bf16_f32 v101, v90, v91
v_mul_f32 v85, v80, v56
v_fmac_f32 v92, v95, v98
v_fmac_f32 v84, v81, v55
ds_write_b32 v45, v101 offset:10296
v_fmac_f32 v85, v81, v54
v_fmac_f32 v93, v95, v96
v_cvt_pk_bf16_f32 v78, v84, v85
v_mul_f32 v88, v90, v96
ds_write_b32 v45, v78 offset:4752
v_cvt_pk_bf16_f32 v103, v92, v93
v_mul_f32 v80, v84, v54
v_mul_f32 v89, v90, v97
v_mul_f32 v81, v84, v56
ds_write_b32 v45, v103 offset:10560
v_fmac_f32 v80, v85, v55
v_fmac_f32 v88, v91, v98
v_fmac_f32 v81, v85, v54
v_mul_f32 v94, v92, v96
v_cvt_pk_bf16_f32 v79, v80, v81
v_fmac_f32 v89, v91, v96
ds_write_b32 v45, v79 offset:5016
v_mul_f32 v95, v92, v97
v_mul_f32 v84, v80, v54
v_cvt_pk_bf16_f32 v100, v88, v89
v_mul_f32 v85, v80, v56
v_fmac_f32 v94, v93, v98
v_fmac_f32 v84, v81, v55
ds_write_b32 v45, v100 offset:10824
v_fmac_f32 v85, v81, v54
v_fmac_f32 v95, v93, v96
v_cvt_pk_bf16_f32 v76, v84, v85
v_mul_f32 v90, v88, v96
ds_write_b32 v45, v76 offset:5280
v_cvt_pk_bf16_f32 v102, v94, v95
v_mul_f32 v91, v88, v97
ds_write_b32 v45, v102 offset:11088
v_fmac_f32 v90, v89, v98
v_mul_f32 v92, v94, v96
v_fmac_f32 v91, v89, v96
v_mul_f32 v93, v94, v97
v_cvt_pk_bf16_f32 v101, v90, v91
v_fmac_f32 v92, v95, v98
ds_write_b32 v45, v101 offset:11352
v_fmac_f32 v93, v95, v96
v_mul_f32 v88, v90, v96
v_cvt_pk_bf16_f32 v103, v92, v93
v_mul_f32 v89, v90, v97
ds_write_b32 v45, v103 offset:11616
v_fmac_f32 v88, v91, v98
v_mul_f32 v94, v92, v96
v_fmac_f32 v89, v91, v96
v_mul_f32 v95, v92, v97
v_cvt_pk_bf16_f32 v100, v88, v89
v_fmac_f32 v94, v93, v98
ds_write_b32 v45, v100 offset:11880
v_fmac_f32 v95, v93, v96
v_mul_f32 v90, v88, v96
v_cvt_pk_bf16_f32 v102, v94, v95
v_mul_f32 v91, v88, v97
ds_write_b32 v45, v102 offset:12144
v_fmac_f32 v90, v89, v98
v_mul_f32 v92, v94, v96
v_fmac_f32 v91, v89, v96
v_mul_f32 v93, v94, v97
v_cvt_pk_bf16_f32 v101, v90, v91
v_fmac_f32 v92, v95, v98
ds_write_b32 v45, v101 offset:12408
v_fmac_f32 v93, v95, v96
v_mul_f32 v88, v90, v96
v_cvt_pk_bf16_f32 v103, v92, v93
v_mul_f32 v89, v90, v97
ds_write_b32 v45, v103 offset:12672
v_fmac_f32 v88, v91, v98
v_mul_f32 v94, v92, v96
v_fmac_f32 v89, v91, v96
v_mul_f32 v95, v92, v97
v_cvt_pk_bf16_f32 v100, v88, v89
v_fmac_f32 v94, v93, v98
ds_write_b32 v45, v100 offset:12936
v_fmac_f32 v95, v93, v96
v_mul_f32 v90, v88, v96
v_cvt_pk_bf16_f32 v102, v94, v95
v_mul_f32 v91, v88, v97
ds_write_b32 v45, v102 offset:13200
v_fmac_f32 v90, v89, v98
v_mul_f32 v92, v94, v96
v_fmac_f32 v91, v89, v96
v_mul_f32 v93, v94, v97
v_cvt_pk_bf16_f32 v101, v90, v91
v_fmac_f32 v92, v95, v98
ds_write_b32 v45, v101 offset:13464
v_fmac_f32 v93, v95, v96
v_cvt_pk_bf16_f32 v103, v92, v93
ds_write_b32 v45, v103 offset:13728
v_lshlrev_b32 v205, 6, v2
s_mov_b32 s54, 16384
buffer_load_dword v204, v205, s[44:47], s54 offen sc1
v_and_b32 v58, 31, v2
v_lshrrev_b32 v59, 5, v2
v_lshlrev_b32 v59, 4, v59
v_add_u32 v59, s50, v59
v_min_u32 v60, 20, v58
v_mul_u32_u24 v60, 264, v60
v_add_u32 v60, v60, v59
v_mul_u32_u24 v58, 264, v58
v_add_u32 v58, v58, v59

v_mov_b32 v88, 0
v_mov_b32 v89, 0
v_mov_b32 v90, 0
v_mov_b32 v91, 0
v_mov_b32 v92, 0
v_mov_b32 v93, 0
v_mov_b32 v94, 0
v_mov_b32 v95, 0
v_mov_b32 v96, 0
v_mov_b32 v97, 0
v_mov_b32 v98, 0
v_mov_b32 v99, 0
v_mov_b32 v100, 0
v_mov_b32 v101, 0
v_mov_b32 v102, 0
v_mov_b32 v103, 0
s_waitcnt lgkmcnt(0)
v_add_u32 v58, 5544, v58
ds_read2_b64 v[104:107], v60 offset0:0 offset1:1
ds_read2_b64 v[108:111], v58 offset0:0 offset1:1
ds_read2_b64 v[112:115], v60 offset0:4 offset1:5
ds_read2_b64 v[116:119], v58 offset0:4 offset1:5
ds_read2_b64 v[120:123], v60 offset0:8 offset1:9
ds_read2_b64 v[124:127], v58 offset0:8 offset1:9
s_waitcnt lgkmcnt(4)
v_mfma_f32_32x32x16_bf16 v[88:103], v[104:107], v[108:111], v[88:103]
ds_read2_b64 v[104:107], v60 offset0:12 offset1:13
ds_read2_b64 v[108:111], v58 offset0:12 offset1:13
s_waitcnt lgkmcnt(4)
v_mfma_f32_32x32x16_bf16 v[88:103], v[112:115], v[116:119], v[88:103]
ds_read2_b64 v[112:115], v60 offset0:16 offset1:17
ds_read2_b64 v[116:119], v58 offset0:16 offset1:17
s_waitcnt lgkmcnt(4)
v_mfma_f32_32x32x16_bf16 v[88:103], v[120:123], v[124:127], v[88:103]
ds_read2_b64 v[120:123], v60 offset0:20 offset1:21
ds_read2_b64 v[124:127], v58 offset0:20 offset1:21
s_waitcnt lgkmcnt(4)
v_mfma_f32_32x32x16_bf16 v[88:103], v[104:107], v[108:111], v[88:103]
ds_read2_b64 v[104:107], v60 offset0:24 offset1:25
ds_read2_b64 v[108:111], v58 offset0:24 offset1:25
s_waitcnt lgkmcnt(4)
v_mfma_f32_32x32x16_bf16 v[88:103], v[112:115], v[116:119], v[88:103]
ds_read2_b64 v[112:115], v60 offset0:28 offset1:29
ds_read2_b64 v[116:119], v58 offset0:28 offset1:29
s_waitcnt lgkmcnt(4)
v_mfma_f32_32x32x16_bf16 v[88:103], v[120:123], v[124:127], v[88:103]
s_waitcnt lgkmcnt(2)
v_mfma_f32_32x32x16_bf16 v[88:103], v[104:107], v[108:111], v[88:103]
s_waitcnt lgkmcnt(0)
v_mfma_f32_32x32x16_bf16 v[88:103], v[112:115], v[116:119], v[88:103]
v_and_b32 v58, 31, v2
v_lshlrev_b32 v58, 2, v58
v_lshrrev_b32 v59, 5, v2
v_lshl_add_u32 v58, v59, 9, v58
v_add_u32 v58, s50, v58
s_nop 15

ds_write_b32 v58, v88 offset:0
ds_write_b32 v58, v89 offset:128
ds_write_b32 v58, v90 offset:256
ds_write_b32 v58, v91 offset:384
ds_write_b32 v58, v92 offset:1024
ds_write_b32 v58, v93 offset:1152
ds_write_b32 v58, v94 offset:1280
ds_write_b32 v58, v95 offset:1408
ds_write_b32 v58, v96 offset:2048
ds_write_b32 v58, v97 offset:2176
ds_write_b32 v58, v98 offset:2304
ds_write_b32 v58, v99 offset:2432
s_waitcnt lgkmcnt(0)
s_barrier
s_waitcnt vmcnt(0)
v_readfirstlane_b32 s69, v200
s_mov_b32 s61, 20000
s_nop 1
s_cmp_lg_u32 s69, 0
s_cbranch_scc1 L_nf_21_d
L_nf_21:
global_load_dword v200, v201, s[62:63] sc1
s_waitcnt vmcnt(0)
v_readfirstlane_b32 s69, v200
s_sub_u32 s61, s61, 1
s_cbranch_scc1 L_nf_21_d
s_cmp_eq_u32 s69, 0
s_cbranch_scc1 L_nf_21
L_nf_21_d:

v_cmp_ne_u32 vcc, s69, v204
s_cbranch_vccz L_xw_22_d
s_mov_b32 s61, 20000
L_xw_22:
buffer_load_dword v204, v205, s[44:47], s54 offen sc1
s_sub_u32 s61, s61, 1
s_cbranch_scc1 L_xw_22_d
s_waitcnt vmcnt(0)
v_cmp_ne_u32 vcc, s69, v204
s_cbranch_vccnz L_xw_22
L_xw_22_d:

s_lshl_b32 s52, s25, 13
v_lshlrev_b32 v207, 5, v0
buffer_load_dwordx4 v[208:211], v207, s[56:59], s52 offen sc1
buffer_load_dwordx4 v[212:215], v207, s[56:59], s52 offen offset:16 sc1

v_lshlrev_b32 v58, 2, v0

ds_read_b32 v88, v58 offset:0
ds_read_b32 v89, v58 offset:13992
ds_read_b32 v90, v58 offset:27984
ds_read_b32 v91, v58 offset:41976
ds_read_b32 v92, v58 offset:1024
ds_read_b32 v93, v58 offset:15016
ds_read_b32 v94, v58 offset:29008
ds_read_b32 v95, v58 offset:43000
ds_read_b32 v96, v58 offset:2048
ds_read_b32 v97, v58 offset:16040
ds_read_b32 v98, v58 offset:30032
ds_read_b32 v99, v58 offset:44024
v_lshrrev_b32 v59, 5, v0
v_and_b32 v60, 31, v0
v_lshlrev_b32 v60, 2, v60
v_lshlrev_b32 v61, 8, v59
v_add_u32 v61, 1024, v61
v_lshlrev_b32 v62, 9, v59
v_cmp_gt_u32 vcc, 4, v59
s_nop 1
v_cndmask_b32 v61, v62, v61, vcc
v_add_u32 v61, v61, v60
v_lshlrev_b32 v62, 10, v59
v_add_u32 v62, v62, v60
s_waitcnt lgkmcnt(0)

v_add_f32 v88, v88, v89
v_add_f32 v90, v90, v91
v_add_f32 v88, v88, v90
v_mul_f32 v88, v88, v44

v_add_f32 v92, v92, v93
v_add_f32 v94, v94, v95
v_add_f32 v92, v92, v94
v_mul_f32 v92, v92, v44

v_add_f32 v96, v96, v97
v_add_f32 v98, v98, v99
v_add_f32 v96, v96, v98
v_mul_f32 v96, v96, v44

ds_write_b32 v58, v88 offset:4096
ds_write_b32 v61, v92 offset:4096
v_cmp_gt_u32 vcc, 5, v59
s_and_saveexec_b64 s[52:53], vcc
ds_write_b32 v62, v96 offset:8192
s_mov_b64 exec, s[52:53]
v_mov_b32 v61, 0
v_mov_b32 v62, 12416
ds_write_b32 v62, v61
s_waitcnt lgkmcnt(0)
s_barrier

ds_read_b32 v88, v24
ds_read_b32 v89, v25
ds_read_b32 v90, v26
ds_read_b32 v91, v27
ds_read_b32 v92, v28
ds_read_b32 v93, v29
ds_read_b32 v94, v30
ds_read_b32 v95, v31
ds_read_b32 v96, v32
v_lshlrev_b32 v58, 4, v0
v_add_u32 v58, 55968, v58
s_waitcnt lgkmcnt(0)
v_cvt_pk_bf16_f32 v104, v89, v90
v_cvt_pk_bf16_f32 v108, v88, v89
v_cvt_pk_bf16_f32 v105, v91, v92
v_cvt_pk_bf16_f32 v109, v90, v91
v_cvt_pk_bf16_f32 v106, v93, v94
v_cvt_pk_bf16_f32 v110, v92, v93
v_cvt_pk_bf16_f32 v107, v95, v96
v_cvt_pk_bf16_f32 v111, v94, v95
ds_write_b128 v58, v[104:107] offset:8320
ds_write_b128 v58, v[108:111] offset:12480
v_cmp_gt_u32 vcc, 4, v0
s_and_saveexec_b64 s[52:53], vcc
s_cbranch_execz L_exp_23
ds_read_b32 v88, v33
ds_read_b32 v89, v34
ds_read_b32 v90, v35
ds_read_b32 v91, v36
ds_read_b32 v92, v37
ds_read_b32 v93, v38
ds_read_b32 v94, v39
ds_read_b32 v95, v40
ds_read_b32 v96, v41
v_lshlrev_b32 v58, 4, v0
v_add_u32 v58, 55968, v58
s_waitcnt lgkmcnt(0)
v_cvt_pk_bf16_f32 v104, v89, v90
v_cvt_pk_bf16_f32 v108, v88, v89
v_cvt_pk_bf16_f32 v105, v91, v92
v_cvt_pk_bf16_f32 v109, v90, v91
v_cvt_pk_bf16_f32 v106, v93, v94
v_cvt_pk_bf16_f32 v110, v92, v93
v_cvt_pk_bf16_f32 v107, v95, v96
v_cvt_pk_bf16_f32 v111, v94, v95
ds_write_b128 v58, v[104:107] offset:12416
ds_write_b128 v58, v[108:111] offset:16576
L_exp_23:
s_mov_b64 exec, s[52:53]
s_waitcnt lgkmcnt(0)
s_barrier
s_setprio 2
v_lshrrev_b32 v6, 7, v0
v_mul_u32_u24 v6, 512, v6
v_add_u32 v6, v6, v207
v_add_u32 v6, 73120, v6
s_waitcnt vmcnt(0)
ds_write_b128 v6, v[208:211]
ds_write_b128 v6, v[212:215] offset:16

s_cmp_eq_u32 s24, 0
s_cbranch_scc1 L_nopf
s_load_dwordx2 s[62:63], s[0:1], 80
s_lshr_b32 s54, s25, 3
s_mul_i32 s54, s54, 57344
v_subrev_u32 v202, 64, v0
v_lshlrev_b32 v202, 7, v202
s_waitcnt lgkmcnt(0)
s_mov_b32 s64, s62
s_mov_b32 s65, s63
s_mov_b32 s66, 1605632
s_mov_b32 s67, 0x20000
s_add_u32 s55, s54, 24576
buffer_load_dword v203, v202, s[64:67], s54 offen
buffer_load_dword v203, v202, s[64:67], s55 offen
s_add_u32 s55, s54, 49152
v_cmp_gt_u32 vcc, 128, v0
s_and_saveexec_b64 s[60:61], vcc
s_cbranch_execz L_nopf2
buffer_load_dword v203, v202, s[64:67], s55 offen
L_nopf2:
s_mov_b64 exec, s[60:61]
L_nopf:
s_waitcnt lgkmcnt(0)
s_barrier
s_lshr_b32 s50, s24, 1
s_and_b32 s51, s24, 1
v_and_b32 v56, 15, v2
v_lshrrev_b32 v57, 4, v2
v_and_b32 v58, 1, v56
v_mul_u32_u24 v58, 4160, v58
v_and_b32 v59, 14, v56
v_lshlrev_b32 v59, 1, v59
v_sub_u32 v58, v58, v59
v_lshl_add_u32 v58, v57, 4, v58
s_mul_i32 s52, s50, 8320
s_lshl_b32 s53, s51, 8
s_sub_u32 s52, s52, s53
s_add_u32 s52, s52, 60032
v_add_u32 v4, s52, v58
v_lshlrev_b32 v58, 5, v56
v_lshl_add_u32 v58, v57, 4, v58
s_mul_i32 s52, s50, 4608
s_sub_u32 s52, s52, s53
s_add_u32 s52, s52, 72832
v_add_u32 v5, s52, v58

v_mov_b32 v24, 0
v_mov_b32 v25, 0
v_mov_b32 v26, 0
v_mov_b32 v27, 0
v_mov_b32 v28, 0
v_mov_b32 v29, 0
v_mov_b32 v30, 0
v_mov_b32 v31, 0
v_mov_b32 v32, 0
v_mov_b32 v33, 0
v_mov_b32 v34, 0
v_mov_b32 v35, 0
v_mov_b32 v36, 0
v_mov_b32 v37, 0
v_mov_b32 v38, 0
v_mov_b32 v39, 0
v_mov_b32 v40, 0
v_mov_b32 v41, 0
v_mov_b32 v42, 0
v_mov_b32 v43, 0
v_mov_b32 v44, 0
v_mov_b32 v45, 0
v_mov_b32 v46, 0
v_mov_b32 v47, 0
v_mov_b32 v48, 0
v_mov_b32 v49, 0
v_mov_b32 v50, 0
v_mov_b32 v51, 0
v_mov_b32 v52, 0
v_mov_b32 v53, 0
v_mov_b32 v54, 0
v_mov_b32 v55, 0
ds_read_b128 v[64:67], v5 offset:256
ds_read_b128 v[68:71], v5 offset:768
ds_read_b128 v[72:75], v5 offset:1280
ds_read_b128 v[76:79], v5 offset:1792
ds_read_b128 v[80:83], v5 offset:2304
ds_read_b128 v[84:87], v5 offset:2816
ds_read_b128 v[88:91], v5 offset:3328
ds_read_b128 v[92:95], v5 offset:3840
v_subrev_u32 v6, 0, v4
ds_read2_b32 v[96:97], v6 offset0:0 offset1:1
ds_read2_b32 v[98:99], v6 offset0:2 offset1:3
v_subrev_u32 v6, 512, v4
ds_read2_b32 v[100:101], v6 offset0:0 offset1:1
ds_read2_b32 v[102:103], v6 offset0:2 offset1:3
v_subrev_u32 v6, 1024, v4
ds_read2_b32 v[104:105], v6 offset0:0 offset1:1
ds_read2_b32 v[106:107], v6 offset0:2 offset1:3
v_subrev_u32 v6, 1536, v4
ds_read2_b32 v[108:109], v6 offset0:0 offset1:1
ds_read2_b32 v[110:111], v6 offset0:2 offset1:3
v_subrev_u32 v6, 2048, v4
ds_read2_b32 v[112:113], v6 offset0:0 offset1:1
ds_read2_b32 v[114:115], v6 offset0:2 offset1:3
v_subrev_u32 v6, 2560, v4
ds_read2_b32 v[116:117], v6 offset0:0 offset1:1
ds_read2_b32 v[118:119], v6 offset0:2 offset1:3
v_subrev_u32 v6, 3072, v4
ds_read2_b32 v[120:121], v6 offset0:0 offset1:1
ds_read2_b32 v[122:123], v6 offset0:2 offset1:3
v_subrev_u32 v6, 3584, v4
ds_read2_b32 v[124:125], v6 offset0:0 offset1:1
ds_read2_b32 v[126:127], v6 offset0:2 offset1:3
s_waitcnt lgkmcnt(0)
v_mfma_f32_16x16x32_bf16 v[52:55], v[96:99], v[92:95], v[52:55]
v_mfma_f32_16x16x32_bf16 v[48:51], v[96:99], v[88:91], v[48:51]
ds_read_b128 v[128:131], v5 offset:192
v_mfma_f32_16x16x32_bf16 v[44:47], v[96:99], v[84:87], v[44:47]
v_mfma_f32_16x16x32_bf16 v[52:55], v[100:103], v[88:91], v[52:55]
ds_read_b128 v[132:135], v5 offset:704
v_mfma_f32_16x16x32_bf16 v[48:51], v[100:103], v[84:87], v[48:51]
v_mfma_f32_16x16x32_bf16 v[44:47], v[100:103], v[80:83], v[44:47]
ds_read_b128 v[136:139], v5 offset:1216
v_mfma_f32_16x16x32_bf16 v[52:55], v[104:107], v[84:87], v[52:55]
v_mfma_f32_16x16x32_bf16 v[48:51], v[104:107], v[80:83], v[48:51]
ds_read_b128 v[140:143], v5 offset:1728
v_mfma_f32_16x16x32_bf16 v[40:43], v[96:99], v[80:83], v[40:43]
v_mfma_f32_16x16x32_bf16 v[52:55], v[108:111], v[80:83], v[52:55]
ds_read_b128 v[144:147], v5 offset:2240
v_mfma_f32_16x16x32_bf16 v[48:51], v[108:111], v[76:79], v[48:51]
v_mfma_f32_16x16x32_bf16 v[44:47], v[104:107], v[76:79], v[44:47]
ds_read_b128 v[148:151], v5 offset:2752
v_mfma_f32_16x16x32_bf16 v[52:55], v[112:115], v[76:79], v[52:55]
v_mfma_f32_16x16x32_bf16 v[40:43], v[100:103], v[76:79], v[40:43]
ds_read_b128 v[152:155], v5 offset:3264
v_mfma_f32_16x16x32_bf16 v[36:39], v[96:99], v[76:79], v[36:39]
v_mfma_f32_16x16x32_bf16 v[52:55], v[116:119], v[72:75], v[52:55]
ds_read_b128 v[156:159], v5 offset:3776
v_mfma_f32_16x16x32_bf16 v[48:51], v[112:115], v[72:75], v[48:51]
v_mfma_f32_16x16x32_bf16 v[44:47], v[108:111], v[72:75], v[44:47]
v_subrev_u32 v6, 64, v4
ds_read2_b32 v[160:161], v6 offset0:0 offset1:1
ds_read2_b32 v[162:163], v6 offset0:2 offset1:3
v_mfma_f32_16x16x32_bf16 v[40:43], v[104:107], v[72:75], v[40:43]
v_mfma_f32_16x16x32_bf16 v[36:39], v[100:103], v[72:75], v[36:39]
v_subrev_u32 v6, 576, v4
ds_read2_b32 v[164:165], v6 offset0:0 offset1:1
ds_read2_b32 v[166:167], v6 offset0:2 offset1:3
v_mfma_f32_16x16x32_bf16 v[32:35], v[96:99], v[72:75], v[32:35]
v_mfma_f32_16x16x32_bf16 v[52:55], v[120:123], v[68:71], v[52:55]
v_subrev_u32 v6, 1088, v4
ds_read2_b32 v[168:169], v6 offset0:0 offset1:1
ds_read2_b32 v[170:171], v6 offset0:2 offset1:3
v_mfma_f32_16x16x32_bf16 v[48:51], v[116:119], v[68:71], v[48:51]
v_mfma_f32_16x16x32_bf16 v[44:47], v[112:115], v[68:71], v[44:47]
v_subrev_u32 v6, 1600, v4
ds_read2_b32 v[172:173], v6 offset0:0 offset1:1
ds_read2_b32 v[174:175], v6 offset0:2 offset1:3
v_mfma_f32_16x16x32_bf16 v[40:43], v[108:111], v[68:71], v[40:43]
v_mfma_f32_16x16x32_bf16 v[36:39], v[104:107], v[68:71], v[36:39]
v_subrev_u32 v6, 2112, v4
ds_read2_b32 v[176:177], v6 offset0:0 offset1:1
ds_read2_b32 v[178:179], v6 offset0:2 offset1:3
v_mfma_f32_16x16x32_bf16 v[32:35], v[100:103], v[68:71], v[32:35]
v_mfma_f32_16x16x32_bf16 v[28:31], v[96:99], v[68:71], v[28:31]
v_subrev_u32 v6, 2624, v4
ds_read2_b32 v[180:181], v6 offset0:0 offset1:1
ds_read2_b32 v[182:183], v6 offset0:2 offset1:3
v_mfma_f32_16x16x32_bf16 v[52:55], v[124:127], v[64:67], v[52:55]
v_mfma_f32_16x16x32_bf16 v[48:51], v[120:123], v[64:67], v[48:51]
v_subrev_u32 v6, 3136, v4
ds_read2_b32 v[184:185], v6 offset0:0 offset1:1
ds_read2_b32 v[186:187], v6 offset0:2 offset1:3
v_mfma_f32_16x16x32_bf16 v[44:47], v[116:119], v[64:67], v[44:47]
v_mfma_f32_16x16x32_bf16 v[40:43], v[112:115], v[64:67], v[40:43]
v_subrev_u32 v6, 3648, v4
ds_read2_b32 v[188:189], v6 offset0:0 offset1:1
ds_read2_b32 v[190:191], v6 offset0:2 offset1:3
v_mfma_f32_16x16x32_bf16 v[36:39], v[108:111], v[64:67], v[36:39]
v_mfma_f32_16x16x32_bf16 v[32:35], v[104:107], v[64:67], v[32:35]
v_mfma_f32_16x16x32_bf16 v[28:31], v[100:103], v[64:67], v[28:31]
v_mfma_f32_16x16x32_bf16 v[24:27], v[96:99], v[64:67], v[24:27]
s_waitcnt lgkmcnt(0)
v_mfma_f32_16x16x32_bf16 v[52:55], v[160:163], v[156:159], v[52:55]
v_mfma_f32_16x16x32_bf16 v[48:51], v[160:163], v[152:155], v[48:51]
ds_read_b128 v[64:67], v5 offset:128
v_mfma_f32_16x16x32_bf16 v[44:47], v[160:163], v[148:151], v[44:47]
v_mfma_f32_16x16x32_bf16 v[52:55], v[164:167], v[152:155], v[52:55]
ds_read_b128 v[68:71], v5 offset:640
v_mfma_f32_16x16x32_bf16 v[48:51], v[164:167], v[148:151], v[48:51]
v_mfma_f32_16x16x32_bf16 v[44:47], v[164:167], v[144:147], v[44:47]
ds_read_b128 v[72:75], v5 offset:1152
v_mfma_f32_16x16x32_bf16 v[52:55], v[168:171], v[148:151], v[52:55]
v_mfma_f32_16x16x32_bf16 v[48:51], v[168:171], v[144:147], v[48:51]
ds_read_b128 v[76:79], v5 offset:1664
v_mfma_f32_16x16x32_bf16 v[40:43], v[160:163], v[144:147], v[40:43]
v_mfma_f32_16x16x32_bf16 v[52:55], v[172:175], v[144:147], v[52:55]
ds_read_b128 v[80:83], v5 offset:2176
v_mfma_f32_16x16x32_bf16 v[48:51], v[172:175], v[140:143], v[48:51]
v_mfma_f32_16x16x32_bf16 v[44:47], v[168:171], v[140:143], v[44:47]
ds_read_b128 v[84:87], v5 offset:2688
v_mfma_f32_16x16x32_bf16 v[52:55], v[176:179], v[140:143], v[52:55]
v_mfma_f32_16x16x32_bf16 v[40:43], v[164:167], v[140:143], v[40:43]
ds_read_b128 v[88:91], v5 offset:3200
v_mfma_f32_16x16x32_bf16 v[36:39], v[160:163], v[140:143], v[36:39]
v_mfma_f32_16x16x32_bf16 v[52:55], v[180:183], v[136:139], v[52:55]
ds_read_b128 v[92:95], v5 offset:3712
v_mfma_f32_16x16x32_bf16 v[48:51], v[176:179], v[136:139], v[48:51]
v_mfma_f32_16x16x32_bf16 v[44:47], v[172:175], v[136:139], v[44:47]
v_subrev_u32 v6, 128, v4
ds_read2_b32 v[96:97], v6 offset0:0 offset1:1
ds_read2_b32 v[98:99], v6 offset0:2 offset1:3
v_mfma_f32_16x16x32_bf16 v[40:43], v[168:171], v[136:139], v[40:43]
v_mfma_f32_16x16x32_bf16 v[36:39], v[164:167], v[136:139], v[36:39]
v_subrev_u32 v6, 640, v4
ds_read2_b32 v[100:101], v6 offset0:0 offset1:1
ds_read2_b32 v[102:103], v6 offset0:2 offset1:3
v_mfma_f32_16x16x32_bf16 v[32:35], v[160:163], v[136:139], v[32:35]
v_mfma_f32_16x16x32_bf16 v[52:55], v[184:187], v[132:135], v[52:55]
v_subrev_u32 v6, 1152, v4
ds_read2_b32 v[104:105], v6 offset0:0 offset1:1
ds_read2_b32 v[106:107], v6 offset0:2 offset1:3
v_mfma_f32_16x16x32_bf16 v[48:51], v[180:183], v[132:135], v[48:51]
v_mfma_f32_16x16x32_bf16 v[44:47], v[176:179], v[132:135], v[44:47]
v_subrev_u32 v6, 1664, v4
ds_read2_b32 v[108:109], v6 offset0:0 offset1:1
ds_read2_b32 v[110:111], v6 offset0:2 offset1:3
v_mfma_f32_16x16x32_bf16 v[40:43], v[172:175], v[132:135], v[40:43]
v_mfma_f32_16x16x32_bf16 v[36:39], v[168:171], v[132:135], v[36:39]
v_subrev_u32 v6, 2176, v4
ds_read2_b32 v[112:113], v6 offset0:0 offset1:1
ds_read2_b32 v[114:115], v6 offset0:2 offset1:3
v_mfma_f32_16x16x32_bf16 v[32:35], v[164:167], v[132:135], v[32:35]
v_mfma_f32_16x16x32_bf16 v[28:31], v[160:163], v[132:135], v[28:31]
v_subrev_u32 v6, 2688, v4
ds_read2_b32 v[116:117], v6 offset0:0 offset1:1
ds_read2_b32 v[118:119], v6 offset0:2 offset1:3
v_mfma_f32_16x16x32_bf16 v[52:55], v[188:191], v[128:131], v[52:55]
v_mfma_f32_16x16x32_bf16 v[48:51], v[184:187], v[128:131], v[48:51]
v_subrev_u32 v6, 3200, v4
ds_read2_b32 v[120:121], v6 offset0:0 offset1:1
ds_read2_b32 v[122:123], v6 offset0:2 offset1:3
v_mfma_f32_16x16x32_bf16 v[44:47], v[180:183], v[128:131], v[44:47]
v_mfma_f32_16x16x32_bf16 v[40:43], v[176:179], v[128:131], v[40:43]
v_subrev_u32 v6, 3712, v4
ds_read2_b32 v[124:125], v6 offset0:0 offset1:1
ds_read2_b32 v[126:127], v6 offset0:2 offset1:3
v_mfma_f32_16x16x32_bf16 v[36:39], v[172:175], v[128:131], v[36:39]
v_mfma_f32_16x16x32_bf16 v[32:35], v[168:171], v[128:131], v[32:35]
v_mfma_f32_16x16x32_bf16 v[28:31], v[164:167], v[128:131], v[28:31]
v_mfma_f32_16x16x32_bf16 v[24:27], v[160:163], v[128:131], v[24:27]
s_waitcnt lgkmcnt(0)
v_mfma_f32_16x16x32_bf16 v[52:55], v[96:99], v[92:95], v[52:55]
v_mfma_f32_16x16x32_bf16 v[48:51], v[96:99], v[88:91], v[48:51]
ds_read_b128 v[128:131], v5 offset:64
v_mfma_f32_16x16x32_bf16 v[44:47], v[96:99], v[84:87], v[44:47]
v_mfma_f32_16x16x32_bf16 v[52:55], v[100:103], v[88:91], v[52:55]
ds_read_b128 v[132:135], v5 offset:576
v_mfma_f32_16x16x32_bf16 v[48:51], v[100:103], v[84:87], v[48:51]
v_mfma_f32_16x16x32_bf16 v[44:47], v[100:103], v[80:83], v[44:47]
ds_read_b128 v[136:139], v5 offset:1088
v_mfma_f32_16x16x32_bf16 v[52:55], v[104:107], v[84:87], v[52:55]
v_mfma_f32_16x16x32_bf16 v[48:51], v[104:107], v[80:83], v[48:51]
ds_read_b128 v[140:143], v5 offset:1600
v_mfma_f32_16x16x32_bf16 v[40:43], v[96:99], v[80:83], v[40:43]
v_mfma_f32_16x16x32_bf16 v[52:55], v[108:111], v[80:83], v[52:55]
ds_read_b128 v[144:147], v5 offset:2112
v_mfma_f32_16x16x32_bf16 v[48:51], v[108:111], v[76:79], v[48:51]
v_mfma_f32_16x16x32_bf16 v[44:47], v[104:107], v[76:79], v[44:47]
ds_read_b128 v[148:151], v5 offset:2624
v_mfma_f32_16x16x32_bf16 v[52:55], v[112:115], v[76:79], v[52:55]
v_mfma_f32_16x16x32_bf16 v[40:43], v[100:103], v[76:79], v[40:43]
ds_read_b128 v[152:155], v5 offset:3136
v_mfma_f32_16x16x32_bf16 v[36:39], v[96:99], v[76:79], v[36:39]
v_mfma_f32_16x16x32_bf16 v[52:55], v[116:119], v[72:75], v[52:55]
ds_read_b128 v[156:159], v5 offset:3648
v_mfma_f32_16x16x32_bf16 v[48:51], v[112:115], v[72:75], v[48:51]
v_mfma_f32_16x16x32_bf16 v[44:47], v[108:111], v[72:75], v[44:47]
v_subrev_u32 v6, 192, v4
ds_read2_b32 v[160:161], v6 offset0:0 offset1:1
ds_read2_b32 v[162:163], v6 offset0:2 offset1:3
v_mfma_f32_16x16x32_bf16 v[40:43], v[104:107], v[72:75], v[40:43]
v_mfma_f32_16x16x32_bf16 v[36:39], v[100:103], v[72:75], v[36:39]
v_subrev_u32 v6, 704, v4
ds_read2_b32 v[164:165], v6 offset0:0 offset1:1
ds_read2_b32 v[166:167], v6 offset0:2 offset1:3
v_mfma_f32_16x16x32_bf16 v[32:35], v[96:99], v[72:75], v[32:35]
v_mfma_f32_16x16x32_bf16 v[52:55], v[120:123], v[68:71], v[52:55]
v_subrev_u32 v6, 1216, v4
ds_read2_b32 v[168:169], v6 offset0:0 offset1:1
ds_read2_b32 v[170:171], v6 offset0:2 offset1:3
v_mfma_f32_16x16x32_bf16 v[48:51], v[116:119], v[68:71], v[48:51]
v_mfma_f32_16x16x32_bf16 v[44:47], v[112:115], v[68:71], v[44:47]
v_subrev_u32 v6, 1728, v4
ds_read2_b32 v[172:173], v6 offset0:0 offset1:1
ds_read2_b32 v[174:175], v6 offset0:2 offset1:3
v_mfma_f32_16x16x32_bf16 v[40:43], v[108:111], v[68:71], v[40:43]
v_mfma_f32_16x16x32_bf16 v[36:39], v[104:107], v[68:71], v[36:39]
v_subrev_u32 v6, 2240, v4
ds_read2_b32 v[176:177], v6 offset0:0 offset1:1
ds_read2_b32 v[178:179], v6 offset0:2 offset1:3
v_mfma_f32_16x16x32_bf16 v[32:35], v[100:103], v[68:71], v[32:35]
v_mfma_f32_16x16x32_bf16 v[28:31], v[96:99], v[68:71], v[28:31]
v_subrev_u32 v6, 2752, v4
ds_read2_b32 v[180:181], v6 offset0:0 offset1:1
ds_read2_b32 v[182:183], v6 offset0:2 offset1:3
v_mfma_f32_16x16x32_bf16 v[52:55], v[124:127], v[64:67], v[52:55]
v_mfma_f32_16x16x32_bf16 v[48:51], v[120:123], v[64:67], v[48:51]
v_subrev_u32 v6, 3264, v4
ds_read2_b32 v[184:185], v6 offset0:0 offset1:1
ds_read2_b32 v[186:187], v6 offset0:2 offset1:3
v_mfma_f32_16x16x32_bf16 v[44:47], v[116:119], v[64:67], v[44:47]
v_mfma_f32_16x16x32_bf16 v[40:43], v[112:115], v[64:67], v[40:43]
v_subrev_u32 v6, 3776, v4
ds_read2_b32 v[188:189], v6 offset0:0 offset1:1
ds_read2_b32 v[190:191], v6 offset0:2 offset1:3
v_mfma_f32_16x16x32_bf16 v[36:39], v[108:111], v[64:67], v[36:39]
v_mfma_f32_16x16x32_bf16 v[32:35], v[104:107], v[64:67], v[32:35]
v_mfma_f32_16x16x32_bf16 v[28:31], v[100:103], v[64:67], v[28:31]
v_mfma_f32_16x16x32_bf16 v[24:27], v[96:99], v[64:67], v[24:27]
s_waitcnt lgkmcnt(0)
v_mfma_f32_16x16x32_bf16 v[52:55], v[160:163], v[156:159], v[52:55]
v_mfma_f32_16x16x32_bf16 v[48:51], v[160:163], v[152:155], v[48:51]
v_mfma_f32_16x16x32_bf16 v[44:47], v[160:163], v[148:151], v[44:47]
v_mfma_f32_16x16x32_bf16 v[52:55], v[164:167], v[152:155], v[52:55]
v_mfma_f32_16x16x32_bf16 v[48:51], v[164:167], v[148:151], v[48:51]
v_mfma_f32_16x16x32_bf16 v[44:47], v[164:167], v[144:147], v[44:47]
v_mfma_f32_16x16x32_bf16 v[52:55], v[168:171], v[148:151], v[52:55]
v_mfma_f32_16x16x32_bf16 v[48:51], v[168:171], v[144:147], v[48:51]
v_mfma_f32_16x16x32_bf16 v[40:43], v[160:163], v[144:147], v[40:43]
v_mfma_f32_16x16x32_bf16 v[52:55], v[172:175], v[144:147], v[52:55]
v_mfma_f32_16x16x32_bf16 v[48:51], v[172:175], v[140:143], v[48:51]
v_mfma_f32_16x16x32_bf16 v[44:47], v[168:171], v[140:143], v[44:47]
v_mfma_f32_16x16x32_bf16 v[52:55], v[176:179], v[140:143], v[52:55]
v_mfma_f32_16x16x32_bf16 v[40:43], v[164:167], v[140:143], v[40:43]
v_mfma_f32_16x16x32_bf16 v[36:39], v[160:163], v[140:143], v[36:39]
v_mfma_f32_16x16x32_bf16 v[52:55], v[180:183], v[136:139], v[52:55]
v_mfma_f32_16x16x32_bf16 v[48:51], v[176:179], v[136:139], v[48:51]
v_mfma_f32_16x16x32_bf16 v[44:47], v[172:175], v[136:139], v[44:47]
v_mfma_f32_16x16x32_bf16 v[40:43], v[168:171], v[136:139], v[40:43]
v_mfma_f32_16x16x32_bf16 v[36:39], v[164:167], v[136:139], v[36:39]
v_mfma_f32_16x16x32_bf16 v[32:35], v[160:163], v[136:139], v[32:35]
v_mfma_f32_16x16x32_bf16 v[52:55], v[184:187], v[132:135], v[52:55]
v_mfma_f32_16x16x32_bf16 v[48:51], v[180:183], v[132:135], v[48:51]
v_mfma_f32_16x16x32_bf16 v[44:47], v[176:179], v[132:135], v[44:47]
v_mfma_f32_16x16x32_bf16 v[40:43], v[172:175], v[132:135], v[40:43]
v_mfma_f32_16x16x32_bf16 v[36:39], v[168:171], v[132:135], v[36:39]
v_mfma_f32_16x16x32_bf16 v[32:35], v[164:167], v[132:135], v[32:35]
v_mfma_f32_16x16x32_bf16 v[28:31], v[160:163], v[132:135], v[28:31]
v_mfma_f32_16x16x32_bf16 v[52:55], v[188:191], v[128:131], v[52:55]
v_mfma_f32_16x16x32_bf16 v[48:51], v[184:187], v[128:131], v[48:51]
v_mfma_f32_16x16x32_bf16 v[44:47], v[180:183], v[128:131], v[44:47]
v_mfma_f32_16x16x32_bf16 v[40:43], v[176:179], v[128:131], v[40:43]
v_mfma_f32_16x16x32_bf16 v[36:39], v[172:175], v[128:131], v[36:39]
v_mfma_f32_16x16x32_bf16 v[32:35], v[168:171], v[128:131], v[32:35]
v_mfma_f32_16x16x32_bf16 v[28:31], v[164:167], v[128:131], v[28:31]
v_mfma_f32_16x16x32_bf16 v[24:27], v[160:163], v[128:131], v[24:27]
s_nop 7
v_lshlrev_b32 v56, 4, v2
s_lshl_b32 s52, s24, 12
v_add_u32 v57, s52, v56
s_xor_b32 s53, s24, 1
s_lshl_b32 s53, s53, 12
v_add_u32 v58, s53, v56
s_cmp_eq_u32 s51, 0

s_cbranch_scc0 L_cv_24
ds_write_b128 v57, v[40:43] offset:0
ds_write_b128 v57, v[44:47] offset:1024
ds_write_b128 v57, v[48:51] offset:2048
ds_write_b128 v57, v[52:55] offset:3072
s_branch L_cv_25
L_cv_24:
ds_write_b128 v57, v[24:27] offset:0
ds_write_b128 v57, v[28:31] offset:1024
ds_write_b128 v57, v[32:35] offset:2048
ds_write_b128 v57, v[36:39] offset:3072
v_mov_b32 v24, v40
v_mov_b32 v25, v41
v_mov_b32 v26, v42
v_mov_b32 v27, v43
v_mov_b32 v28, v44
v_mov_b32 v29, v45
v_mov_b32 v30, v46
v_mov_b32 v31, v47
v_mov_b32 v32, v48
v_mov_b32 v33, v49
v_mov_b32 v34, v50
v_mov_b32 v35, v51
v_mov_b32 v36, v52
v_mov_b32 v37, v53
v_mov_b32 v38, v54
v_mov_b32 v39, v55
L_cv_25:
s_waitcnt lgkmcnt(0)
s_barrier
ds_read_b128 v[64:67], v58 offset:0
ds_read_b128 v[68:71], v58 offset:1024
ds_read_b128 v[72:75], v58 offset:2048
ds_read_b128 v[76:79], v58 offset:3072
v_and_b32 v56, 15, v2
v_lshrrev_b32 v57, 4, v2
v_lshlrev_b32 v56, 5, v56
v_lshl_add_u32 v56, v57, 3, v56
s_lshl_b32 s52, s51, 11
v_add_u32 v59, s52, v56
s_mul_i32 s53, s50, 4608
s_add_u32 s53, s53, 73120
v_add_u32 v57, s53, v59

ds_read_b64 v[80:81], v57 offset:0
ds_read_b64 v[82:83], v57 offset:512
ds_read_b64 v[84:85], v57 offset:1024
ds_read_b64 v[86:87], v57 offset:1536
s_cmp_eq_u32 s50, 0
s_cselect_b64 vcc, -1, 0
s_lshl_b32 s52, s25, 1
s_add_u32 s52, s52, s50
s_lshl_b32 s52, s52, 12
v_cndmask_b32 v60, v21, v13, vcc
s_waitcnt lgkmcnt(0)

v_add_f32 v24, v24, v64
v_add_f32 v25, v25, v65
v_add_f32 v26, v26, v66
v_add_f32 v27, v27, v67
v_lshlrev_b32 v90, 16, v80
v_and_b32 v91, 0xffff0000, v80
v_lshlrev_b32 v92, 16, v81
v_and_b32 v93, 0xffff0000, v81
v_mul_f32 v90, v90, v60
v_mul_f32 v91, v91, v60
v_mul_f32 v92, v92, v60
v_mul_f32 v93, v93, v60
v_cvt_pk_bf16_f32 v94, v90, v91
v_cvt_pk_bf16_f32 v95, v92, v93
v_cvt_pk_bf16_f32 v96, v24, v25
v_cvt_pk_bf16_f32 v97, v26, v27
v_lshlrev_b32 v90, 16, v94
v_and_b32 v91, 0xffff0000, v94
v_lshlrev_b32 v92, 16, v95
v_and_b32 v93, 0xffff0000, v95
v_lshlrev_b32 v98, 16, v96
v_and_b32 v99, 0xffff0000, v96
v_lshlrev_b32 v100, 16, v97
v_and_b32 v101, 0xffff0000, v97
v_add_f32 v90, v90, v98
v_add_f32 v91, v91, v99
v_add_f32 v92, v92, v100
v_add_f32 v93, v93, v101
v_cvt_pk_bf16_f32 v102, v90, v91
v_cvt_pk_bf16_f32 v103, v92, v93
buffer_store_dwordx2 v[102:103], v59, s[32:35], s52 offen offset:0 sc1

v_add_f32 v28, v28, v68
v_add_f32 v29, v29, v69
v_add_f32 v30, v30, v70
v_add_f32 v31, v31, v71
v_lshlrev_b32 v90, 16, v82
v_and_b32 v91, 0xffff0000, v82
v_lshlrev_b32 v92, 16, v83
v_and_b32 v93, 0xffff0000, v83
v_mul_f32 v90, v90, v60
v_mul_f32 v91, v91, v60
v_mul_f32 v92, v92, v60
v_mul_f32 v93, v93, v60
v_cvt_pk_bf16_f32 v94, v90, v91
v_cvt_pk_bf16_f32 v95, v92, v93
v_cvt_pk_bf16_f32 v96, v28, v29
v_cvt_pk_bf16_f32 v97, v30, v31
v_lshlrev_b32 v90, 16, v94
v_and_b32 v91, 0xffff0000, v94
v_lshlrev_b32 v92, 16, v95
v_and_b32 v93, 0xffff0000, v95
v_lshlrev_b32 v98, 16, v96
v_and_b32 v99, 0xffff0000, v96
v_lshlrev_b32 v100, 16, v97
v_and_b32 v101, 0xffff0000, v97
v_add_f32 v90, v90, v98
v_add_f32 v91, v91, v99
v_add_f32 v92, v92, v100
v_add_f32 v93, v93, v101
v_cvt_pk_bf16_f32 v104, v90, v91
v_cvt_pk_bf16_f32 v105, v92, v93
buffer_store_dwordx2 v[104:105], v59, s[32:35], s52 offen offset:512 sc1

v_add_f32 v32, v32, v72
v_add_f32 v33, v33, v73
v_add_f32 v34, v34, v74
v_add_f32 v35, v35, v75
v_lshlrev_b32 v90, 16, v84
v_and_b32 v91, 0xffff0000, v84
v_lshlrev_b32 v92, 16, v85
v_and_b32 v93, 0xffff0000, v85
v_mul_f32 v90, v90, v60
v_mul_f32 v91, v91, v60
v_mul_f32 v92, v92, v60
v_mul_f32 v93, v93, v60
v_cvt_pk_bf16_f32 v94, v90, v91
v_cvt_pk_bf16_f32 v95, v92, v93
v_cvt_pk_bf16_f32 v96, v32, v33
v_cvt_pk_bf16_f32 v97, v34, v35
v_lshlrev_b32 v90, 16, v94
v_and_b32 v91, 0xffff0000, v94
v_lshlrev_b32 v92, 16, v95
v_and_b32 v93, 0xffff0000, v95
v_lshlrev_b32 v98, 16, v96
v_and_b32 v99, 0xffff0000, v96
v_lshlrev_b32 v100, 16, v97
v_and_b32 v101, 0xffff0000, v97
v_add_f32 v90, v90, v98
v_add_f32 v91, v91, v99
v_add_f32 v92, v92, v100
v_add_f32 v93, v93, v101
v_cvt_pk_bf16_f32 v106, v90, v91
v_cvt_pk_bf16_f32 v107, v92, v93
buffer_store_dwordx2 v[106:107], v59, s[32:35], s52 offen offset:1024 sc1

v_add_f32 v36, v36, v76
v_add_f32 v37, v37, v77
v_add_f32 v38, v38, v78
v_add_f32 v39, v39, v79
v_lshlrev_b32 v90, 16, v86
v_and_b32 v91, 0xffff0000, v86
v_lshlrev_b32 v92, 16, v87
v_and_b32 v93, 0xffff0000, v87
v_mul_f32 v90, v90, v60
v_mul_f32 v91, v91, v60
v_mul_f32 v92, v92, v60
v_mul_f32 v93, v93, v60
v_cvt_pk_bf16_f32 v94, v90, v91
v_cvt_pk_bf16_f32 v95, v92, v93
v_cvt_pk_bf16_f32 v96, v36, v37
v_cvt_pk_bf16_f32 v97, v38, v39
v_lshlrev_b32 v90, 16, v94
v_and_b32 v91, 0xffff0000, v94
v_lshlrev_b32 v92, 16, v95
v_and_b32 v93, 0xffff0000, v95
v_lshlrev_b32 v98, 16, v96
v_and_b32 v99, 0xffff0000, v96
v_lshlrev_b32 v100, 16, v97
v_and_b32 v101, 0xffff0000, v97
v_add_f32 v90, v90, v98
v_add_f32 v91, v91, v99
v_add_f32 v92, v92, v100
v_add_f32 v93, v93, v101
v_cvt_pk_bf16_f32 v108, v90, v91
v_cvt_pk_bf16_f32 v109, v92, v93
buffer_store_dwordx2 v[108:109], v59, s[32:35], s52 offen offset:1536 sc1

s_lshl_b32 s54, s25, 6
s_add_u32 s54, s54, 32768
s_waitcnt vmcnt(0)
s_barrier
v_cmp_eq_u32 vcc, 0, v0
s_and_saveexec_b64 s[60:61], vcc
s_cbranch_execz L_sg_26
v_mov_b32 v88, s69
v_mov_b32 v89, 0
buffer_store_dword v88, v89, s[44:47], s54 offen sc1
L_sg_26:
s_mov_b64 exec, s[60:61]

s_add_u32 s2, s2, 288
L_fin:
L_end:
s_endpgm
.section .rodata,"a"
.p2align 6
.amdhsa_kernel recurrent_scan__ssm_conv_s4d__dense_activation_mish__prompt_kernel
.amdhsa_next_free_vgpr 224
.amdhsa_next_free_sgpr 102
.amdhsa_accum_offset 224
.amdhsa_group_segment_fixed_size 0
.amdhsa_kernarg_size 112
.amdhsa_user_sgpr_count 2
.amdhsa_user_sgpr_kernarg_segment_ptr 1
.amdhsa_system_sgpr_workgroup_id_x 1
.end_amdhsa_kernel
```
